```python
import torch

def _softmax(x, axis=-1):
    return torch.softmax(x, dim=axis)
def _gelu(x):
    return torch.nn.functional.gelu(x, approximate="tanh")
def _silu(x):
    return torch.nn.functional.silu(x)
def _sigmoid(x):
    return torch.sigmoid(x)
def _layernorm(x, axis=-1, eps=1e-5):
    m = x.mean(dim=axis, keepdim=True)
    v = x.var(dim=axis, keepdim=True, unbiased=False)
    return (x - m) / torch.sqrt(v + eps)
def _scatter_add(tgt, idx, src, axis=0):
    return tgt.clone().index_add_(axis, idx, src)
def _segment_sum(src, seg, n):
    out = torch.zeros((n,) + src.shape[1:], dtype=src.dtype)
    return out.index_add_(0, seg, src)
def _pad(x, pw):
    flat = tuple(v for pair in reversed(pw) for v in pair)
    return torch.nn.functional.pad(x, flat)

kernel_name = 'recurrent_scan__sliding_block__glu_gated_geglu__prompt'

def setup_inputs():

    _w = (lambda a: (lambda t: t.to(torch.bfloat16) if t.is_floating_point() else t)(torch.as_tensor(a)))
    def _A_setup():
        B, S, D = 1, 2048, 512
        return {
            "x": _w((lambda *s: torch.randn(*s, dtype=torch.bfloat16) * 0.05)(B, S, D)),
            "wqkv": _w((lambda *s: torch.randn(*s, dtype=torch.bfloat16) * 0.2)(D, 3 * D)),
            "wo": _w((lambda *s: torch.randn(*s, dtype=torch.bfloat16) * 0.2)(D, D)),
        }
    _A_in = _A_setup()

    def _B_setup():
        B, S, Dm, Df = 1, 2048, 512, 1792
        return {
            "x": _w((lambda *s: torch.randn(*s, dtype=torch.bfloat16) * 0.05)(B, S, Dm)),
            "w_gate": _w((lambda *s: torch.randn(*s, dtype=torch.bfloat16) * 0.1)(Dm, Df) * (Dm ** -0.5)),
            "w_up": _w((lambda *s: torch.randn(*s, dtype=torch.bfloat16) * 0.1)(Dm, Df) * (Dm ** -0.5)),
            "w_down": _w((lambda *s: torch.randn(*s, dtype=torch.bfloat16) * 0.1)(Df, Dm) * (Df ** -0.5)),
        }
    _B_in = _B_setup()

    return {
        "A_x": _A_in["x"],
        "A_wqkv": _A_in["wqkv"],
        "A_wo": _A_in["wo"],
        "B_x": _B_in["x"],
        "B_w_gate": _B_in["w_gate"],
        "B_w_up": _B_in["w_up"],
        "B_w_down": _B_in["w_down"],
    }

def reference(A_x, A_wqkv, A_wo, B_x, B_w_gate, B_w_up, B_w_down):
    def _A_ref(x, wqkv, wo):
        B, S, D = x.shape
        H = 32; Dh = D // H; W = 256
        qkv = (lambda x, *d: x.permute(*d))((x @ wqkv).reshape(B, S, 3, H, Dh), 2, 0, 3, 1, 4)
        q, k, v = qkv[0], qkv[1], qkv[2]
        scores = torch.einsum("bhqd,bhkd->bhqk", q, k) * (Dh ** -0.5)
        idx = torch.arange(S)
        mask = (idx[:, None] - idx[None, :] >= 0) & (idx[:, None] - idx[None, :] < W)
        scores = torch.where(mask[None, None], scores, -1e9)
        p = _softmax(scores, axis=-1)
        o = torch.einsum("bhqk,bhkd->bhqd", p, v)
        return (lambda x, *d: x.permute(*d))(o, 0, 2, 1, 3).reshape(B, S, D) @ wo

    def _B_ref(x, w_gate, w_up, w_down):
        g = torch.einsum("bsd,df->bsf", x, w_gate)
        u = torch.einsum("bsd,df->bsf", x, w_up)
        h = _gelu(g) * u
        return torch.einsum("bsf,fd->bsd", h, w_down)

    x = A_x
    xn = _layernorm(x, axis=-1)
    s = _A_ref(xn, A_wqkv, A_wo)
    g = _silu(_B_ref(xn, B_w_gate, B_w_up, B_w_down))
    return x + s * g
```

```asm
; @launch kernel=k1_kernel grid=(256,1,1) block=(256,1,1) lds=131072
; @launch kernel=k2_kernel grid=(512,1,1) block=(256,1,1) lds=0
; @launch kernel=k3_kernel grid=(256,1,1) block=(256,1,1) lds=147456
.amdgcn_target "amdgcn-amd-amdhsa--gfx950"
.text
.globl k1_kernel
.p2align 8
.type k1_kernel,@function
k1_kernel:
  s_cmp_ge_u32 s2, 256
  s_cbranch_scc1 L_k1_end
  s_load_dwordx4 s[40:43], s[0:1], 0
  s_load_dwordx4 s[44:47], s[0:1], 32
  s_load_dwordx2 s[48:49], s[0:1], 72
  s_and_b32 s4, s2, 15
  s_lshr_b32 s5, s2, 4
  v_and_b32 v180, 63, v0
  v_lshrrev_b32 v190, 6, v0
  s_nop 0
  v_readfirstlane_b32 s3, v190
  v_and_b32 v181, 31, v180
  v_lshrrev_b32 v182, 5, v180
  s_waitcnt lgkmcnt(0)
  s_mov_b32 s8, s40
  s_and_b32 s9, s41, 0xffff
  s_mov_b32 s10, 0x200000
  s_mov_b32 s11, 0x20000
  s_mov_b32 s12, s42
  s_and_b32 s13, s43, 0xffff
  s_mov_b32 s14, 0x180000
  s_mov_b32 s15, 0x20000
  s_mov_b32 s16, s44
  s_and_b32 s17, s45, 0xffff
  s_mov_b32 s18, 0x1c0000
  s_mov_b32 s19, 0x20000
  s_mov_b32 s20, s46
  s_and_b32 s21, s47, 0xffff
  s_mov_b32 s22, 0x1c0000
  s_mov_b32 s23, 0x20000
  s_mov_b32 s24, s48
  s_and_b32 s25, s49, 0xffff
  s_mov_b32 s26, 0x1000000
  s_mov_b32 s27, 0x20000
  s_lshl_b32 s50, s5, 7
  s_lshl_b32 s51, s3, 5
  s_add_u32 s50, s50, s51
  v_add_u32 v190, s50, v181
  v_lshlrev_b32 v183, 5, v190
  v_lshlrev_b32 v191, 4, v182
  v_add_u32 v183, v183, v191
  s_movk_i32 s52, 3584
  v_mul_lo_u32 v184, v190, s52
  v_add_u32 v184, v184, v191
  v_lshlrev_b32 v185, 12, v181
  v_add_u32 v185, v185, v191
  s_lshl_b32 s53, s50, 1
  v_add_u32 v185, s53, v185
  v_lshrrev_b32 v192, 2, v180
  v_and_b32 v192, 3, v192
  v_lshlrev_b32 v193, 5, v182
  v_add_u32 v192, v192, v193
  v_lshlrev_b32 v192, 6, v192
  v_lshrrev_b32 v193, 4, v180
  v_and_b32 v193, 1, v193
  v_lshlrev_b32 v193, 5, v193
  v_and_b32 v194, 3, v180
  v_lshlrev_b32 v194, 3, v194
  v_add_u32 v176, v192, v193
  v_add_u32 v176, v176, v194
  v_lshrrev_b32 v192, 2, v180
  s_lshl_b32 s53, s3, 4
  v_add_u32 v192, s53, v192
  v_lshlrev_b32 v193, 4, v194
  v_lshrrev_b32 v193, 3, v193
  s_movk_i32 s53, 3072
  v_mul_lo_u32 v178, v192, s53
  v_add_u32 v178, v178, v193
  v_mul_lo_u32 v179, v192, s52
  v_add_u32 v179, v179, v193
  s_lshl_b32 s56, s3, 10
  s_mul_i32 s7, s4, 5
  s_mov_b32 s6, 0
  s_mov_b32 s57, s7
  s_mov_b32 s62, s56
  s_min_u32 s54, s57, 79
  s_cmp_lt_u32 s54, 24
  s_cbranch_scc0 L_k1_gu0
  s_mov_b32 s28, s12
  s_mov_b32 s32, s12
  s_mov_b32 s29, s13
  s_mov_b32 s33, s13
  s_mov_b32 s30, s14
  s_mov_b32 s34, s14
  s_mov_b32 s31, s15
  s_mov_b32 s35, s15
  s_lshl_b32 s36, s54, 7
  s_add_u32 s37, s36, 64
  s_mov_b32 s38, 196608
  v_mov_b32 v177, v178
  s_branch L_k1_sd0
L_k1_gu0:
  s_nop 7
  s_nop 4
  s_mov_b32 s28, s16
  s_mov_b32 s32, s20
  s_mov_b32 s29, s17
  s_mov_b32 s33, s21
  s_mov_b32 s30, s18
  s_mov_b32 s34, s22
  s_mov_b32 s31, s19
  s_mov_b32 s35, s23
  s_sub_u32 s36, s54, 24
  s_lshl_b32 s36, s36, 6
  s_mov_b32 s37, s36
  s_mov_b32 s38, 229376
  v_mov_b32 v177, v179
L_k1_sd0:
  s_nop 7
  s_nop 4
  s_add_u32 s55, s62, 0
  s_mov_b32 m0, s55
  s_nop 0
  buffer_load_dwordx4 v177, s[28:31], s36 offen lds
  s_add_u32 s55, s62, 4096
  s_mov_b32 m0, s55
  s_nop 0
  buffer_load_dwordx4 v177, s[32:35], s37 offen lds
  s_add_u32 s36, s36, s38
  s_add_u32 s37, s37, s38
  s_add_u32 s55, s62, 8192
  s_mov_b32 m0, s55
  s_nop 0
  buffer_load_dwordx4 v177, s[28:31], s36 offen lds
  s_add_u32 s55, s62, 12288
  s_mov_b32 m0, s55
  s_nop 0
  buffer_load_dwordx4 v177, s[32:35], s37 offen lds
  s_add_u32 s36, s36, s38
  s_add_u32 s37, s37, s38
  s_add_u32 s55, s62, 16384
  s_mov_b32 m0, s55
  s_nop 0
  buffer_load_dwordx4 v177, s[28:31], s36 offen lds
  s_add_u32 s55, s62, 20480
  s_mov_b32 m0, s55
  s_nop 0
  buffer_load_dwordx4 v177, s[32:35], s37 offen lds
  s_add_u32 s36, s36, s38
  s_add_u32 s37, s37, s38
  s_add_u32 s55, s62, 24576
  s_mov_b32 m0, s55
  s_nop 0
  buffer_load_dwordx4 v177, s[28:31], s36 offen lds
  s_add_u32 s55, s62, 28672
  s_mov_b32 m0, s55
  s_nop 0
  buffer_load_dwordx4 v177, s[32:35], s37 offen lds
  s_add_u32 s36, s36, s38
  s_add_u32 s37, s37, s38
  s_add_u32 s55, s62, 32768
  s_mov_b32 m0, s55
  s_nop 0
  buffer_load_dwordx4 v177, s[28:31], s36 offen lds
  s_add_u32 s55, s62, 36864
  s_mov_b32 m0, s55
  s_nop 0
  buffer_load_dwordx4 v177, s[32:35], s37 offen lds
  s_add_u32 s36, s36, s38
  s_add_u32 s37, s37, s38
  s_add_u32 s55, s62, 40960
  s_mov_b32 m0, s55
  s_nop 0
  buffer_load_dwordx4 v177, s[28:31], s36 offen lds
  s_add_u32 s55, s62, 45056
  s_mov_b32 m0, s55
  s_nop 0
  buffer_load_dwordx4 v177, s[32:35], s37 offen lds
  s_add_u32 s36, s36, s38
  s_add_u32 s37, s37, s38
  s_add_u32 s55, s62, 49152
  s_mov_b32 m0, s55
  s_nop 0
  buffer_load_dwordx4 v177, s[28:31], s36 offen lds
  s_add_u32 s55, s62, 53248
  s_mov_b32 m0, s55
  s_nop 0
  buffer_load_dwordx4 v177, s[32:35], s37 offen lds
  s_add_u32 s36, s36, s38
  s_add_u32 s37, s37, s38
  s_add_u32 s55, s62, 57344
  s_mov_b32 m0, s55
  s_nop 0
  buffer_load_dwordx4 v177, s[28:31], s36 offen lds
  s_add_u32 s55, s62, 61440
  s_mov_b32 m0, s55
  s_nop 0
  buffer_load_dwordx4 v177, s[32:35], s37 offen lds
  s_add_u32 s36, s36, s38
  s_add_u32 s37, s37, s38
  v_lshrrev_b32 v192, 4, v180
  v_and_b32 v193, 15, v180
  s_lshl_b32 s58, s3, 14
  s_add_u32 s58, s58, 65536
  v_and_b32 v196, 15, v181
  v_lshlrev_b32 v197, 2, v182
  v_add_u32 v198, 0, v197
  v_xor_b32 v198, v198, v196
  v_lshlrev_b32 v198, 4, v198
  v_lshlrev_b32 v212, 8, v181
  v_add_u32 v212, v212, v198
  v_add_u32 v212, s58, v212
  v_add_u32 v198, 8, v197
  v_xor_b32 v198, v198, v196
  v_lshlrev_b32 v198, 4, v198
  v_lshlrev_b32 v213, 8, v181
  v_add_u32 v213, v213, v198
  v_add_u32 v213, s58, v213
  v_add_u32 v198, 1, v197
  v_xor_b32 v198, v198, v196
  v_lshlrev_b32 v198, 4, v198
  v_lshlrev_b32 v214, 8, v181
  v_add_u32 v214, v214, v198
  v_add_u32 v214, s58, v214
  v_add_u32 v198, 9, v197
  v_xor_b32 v198, v198, v196
  v_lshlrev_b32 v198, 4, v198
  v_lshlrev_b32 v215, 8, v181
  v_add_u32 v215, v215, v198
  v_add_u32 v215, s58, v215
  v_add_u32 v198, 2, v197
  v_xor_b32 v198, v198, v196
  v_lshlrev_b32 v198, 4, v198
  v_lshlrev_b32 v216, 8, v181
  v_add_u32 v216, v216, v198
  v_add_u32 v216, s58, v216
  v_add_u32 v198, 10, v197
  v_xor_b32 v198, v198, v196
  v_lshlrev_b32 v198, 4, v198
  v_lshlrev_b32 v217, 8, v181
  v_add_u32 v217, v217, v198
  v_add_u32 v217, s58, v217
  v_add_u32 v198, 3, v197
  v_xor_b32 v198, v198, v196
  v_lshlrev_b32 v198, 4, v198
  v_lshlrev_b32 v218, 8, v181
  v_add_u32 v218, v218, v198
  v_add_u32 v218, s58, v218
  v_add_u32 v198, 11, v197
  v_xor_b32 v198, v198, v196
  v_lshlrev_b32 v198, 4, v198
  v_lshlrev_b32 v219, 8, v181
  v_add_u32 v219, v219, v198
  v_add_u32 v219, s58, v219
  v_add_u32 v194, 0, v192
  v_and_b32 v195, 15, v194
  v_xor_b32 v195, v193, v195
  v_add_u32 v194, s50, v194
  v_lshlrev_b32 v194, 10, v194
  v_lshlrev_b32 v195, 4, v195
  v_add_u32 v220, v194, v195
  v_add_u32 v194, 4, v192
  v_and_b32 v195, 15, v194
  v_xor_b32 v195, v193, v195
  v_add_u32 v194, s50, v194
  v_lshlrev_b32 v194, 10, v194
  v_lshlrev_b32 v195, 4, v195
  v_add_u32 v221, v194, v195
  v_add_u32 v194, 8, v192
  v_and_b32 v195, 15, v194
  v_xor_b32 v195, v193, v195
  v_add_u32 v194, s50, v194
  v_lshlrev_b32 v194, 10, v194
  v_lshlrev_b32 v195, 4, v195
  v_add_u32 v222, v194, v195
  v_add_u32 v194, 12, v192
  v_and_b32 v195, 15, v194
  v_xor_b32 v195, v193, v195
  v_add_u32 v194, s50, v194
  v_lshlrev_b32 v194, 10, v194
  v_lshlrev_b32 v195, 4, v195
  v_add_u32 v223, v194, v195
  v_add_u32 v194, 16, v192
  v_and_b32 v195, 15, v194
  v_xor_b32 v195, v193, v195
  v_add_u32 v194, s50, v194
  v_lshlrev_b32 v194, 10, v194
  v_lshlrev_b32 v195, 4, v195
  v_add_u32 v224, v194, v195
  v_add_u32 v194, 20, v192
  v_and_b32 v195, 15, v194
  v_xor_b32 v195, v193, v195
  v_add_u32 v194, s50, v194
  v_lshlrev_b32 v194, 10, v194
  v_lshlrev_b32 v195, 4, v195
  v_add_u32 v225, v194, v195
  v_add_u32 v194, 24, v192
  v_and_b32 v195, 15, v194
  v_xor_b32 v195, v193, v195
  v_add_u32 v194, s50, v194
  v_lshlrev_b32 v194, 10, v194
  v_lshlrev_b32 v195, 4, v195
  v_add_u32 v226, v194, v195
  v_add_u32 v194, 28, v192
  v_and_b32 v195, 15, v194
  v_xor_b32 v195, v193, v195
  v_add_u32 v194, s50, v194
  v_lshlrev_b32 v194, 10, v194
  v_lshlrev_b32 v195, 4, v195
  v_add_u32 v227, v194, v195
  s_movk_i32 s61, 0
  s_add_u32 s55, s58, 0
  s_mov_b32 m0, s55
  s_nop 0
  buffer_load_dwordx4 v220, s[8:11], s61 offen lds
  s_add_u32 s55, s58, 1024
  s_mov_b32 m0, s55
  s_nop 0
  buffer_load_dwordx4 v221, s[8:11], s61 offen lds
  s_add_u32 s55, s58, 2048
  s_mov_b32 m0, s55
  s_nop 0
  buffer_load_dwordx4 v222, s[8:11], s61 offen lds
  s_add_u32 s55, s58, 3072
  s_mov_b32 m0, s55
  s_nop 0
  buffer_load_dwordx4 v223, s[8:11], s61 offen lds
  s_add_u32 s55, s58, 4096
  s_mov_b32 m0, s55
  s_nop 0
  buffer_load_dwordx4 v224, s[8:11], s61 offen lds
  s_add_u32 s55, s58, 5120
  s_mov_b32 m0, s55
  s_nop 0
  buffer_load_dwordx4 v225, s[8:11], s61 offen lds
  s_add_u32 s55, s58, 6144
  s_mov_b32 m0, s55
  s_nop 0
  buffer_load_dwordx4 v226, s[8:11], s61 offen lds
  s_add_u32 s55, s58, 7168
  s_mov_b32 m0, s55
  s_nop 0
  buffer_load_dwordx4 v227, s[8:11], s61 offen lds
  s_movk_i32 s61, 256
  s_add_u32 s55, s58, 8192
  s_mov_b32 m0, s55
  s_nop 0
  buffer_load_dwordx4 v220, s[8:11], s61 offen lds
  s_add_u32 s55, s58, 9216
  s_mov_b32 m0, s55
  s_nop 0
  buffer_load_dwordx4 v221, s[8:11], s61 offen lds
  s_add_u32 s55, s58, 10240
  s_mov_b32 m0, s55
  s_nop 0
  buffer_load_dwordx4 v222, s[8:11], s61 offen lds
  s_add_u32 s55, s58, 11264
  s_mov_b32 m0, s55
  s_nop 0
  buffer_load_dwordx4 v223, s[8:11], s61 offen lds
  s_add_u32 s55, s58, 12288
  s_mov_b32 m0, s55
  s_nop 0
  buffer_load_dwordx4 v224, s[8:11], s61 offen lds
  s_add_u32 s55, s58, 13312
  s_mov_b32 m0, s55
  s_nop 0
  buffer_load_dwordx4 v225, s[8:11], s61 offen lds
  s_add_u32 s55, s58, 14336
  s_mov_b32 m0, s55
  s_nop 0
  buffer_load_dwordx4 v226, s[8:11], s61 offen lds
  s_add_u32 s55, s58, 15360
  s_mov_b32 m0, s55
  s_nop 0
  buffer_load_dwordx4 v227, s[8:11], s61 offen lds
  s_waitcnt vmcnt(8)
  ds_read_b128 v[0:3], v212 offset:0
  ds_read_b128 v[4:7], v214 offset:0
  ds_read_b128 v[8:11], v216 offset:0
  ds_read_b128 v[12:15], v218 offset:0
  ds_read_b128 v[16:19], v213 offset:0
  ds_read_b128 v[20:23], v215 offset:0
  ds_read_b128 v[24:27], v217 offset:0
  ds_read_b128 v[28:31], v219 offset:0
  s_waitcnt lgkmcnt(0)
  s_movk_i32 s61, 512
  s_add_u32 s55, s58, 0
  s_mov_b32 m0, s55
  s_nop 0
  buffer_load_dwordx4 v220, s[8:11], s61 offen lds
  s_add_u32 s55, s58, 1024
  s_mov_b32 m0, s55
  s_nop 0
  buffer_load_dwordx4 v221, s[8:11], s61 offen lds
  s_add_u32 s55, s58, 2048
  s_mov_b32 m0, s55
  s_nop 0
  buffer_load_dwordx4 v222, s[8:11], s61 offen lds
  s_add_u32 s55, s58, 3072
  s_mov_b32 m0, s55
  s_nop 0
  buffer_load_dwordx4 v223, s[8:11], s61 offen lds
  s_add_u32 s55, s58, 4096
  s_mov_b32 m0, s55
  s_nop 0
  buffer_load_dwordx4 v224, s[8:11], s61 offen lds
  s_add_u32 s55, s58, 5120
  s_mov_b32 m0, s55
  s_nop 0
  buffer_load_dwordx4 v225, s[8:11], s61 offen lds
  s_add_u32 s55, s58, 6144
  s_mov_b32 m0, s55
  s_nop 0
  buffer_load_dwordx4 v226, s[8:11], s61 offen lds
  s_add_u32 s55, s58, 7168
  s_mov_b32 m0, s55
  s_nop 0
  buffer_load_dwordx4 v227, s[8:11], s61 offen lds
  s_waitcnt vmcnt(8)
  ds_read_b128 v[32:35], v212 offset:8192
  ds_read_b128 v[36:39], v214 offset:8192
  ds_read_b128 v[40:43], v216 offset:8192
  ds_read_b128 v[44:47], v218 offset:8192
  ds_read_b128 v[48:51], v213 offset:8192
  ds_read_b128 v[52:55], v215 offset:8192
  ds_read_b128 v[56:59], v217 offset:8192
  ds_read_b128 v[60:63], v219 offset:8192
  s_waitcnt lgkmcnt(0)
  s_movk_i32 s61, 768
  s_add_u32 s55, s58, 8192
  s_mov_b32 m0, s55
  s_nop 0
  buffer_load_dwordx4 v220, s[8:11], s61 offen lds
  s_add_u32 s55, s58, 9216
  s_mov_b32 m0, s55
  s_nop 0
  buffer_load_dwordx4 v221, s[8:11], s61 offen lds
  s_add_u32 s55, s58, 10240
  s_mov_b32 m0, s55
  s_nop 0
  buffer_load_dwordx4 v222, s[8:11], s61 offen lds
  s_add_u32 s55, s58, 11264
  s_mov_b32 m0, s55
  s_nop 0
  buffer_load_dwordx4 v223, s[8:11], s61 offen lds
  s_add_u32 s55, s58, 12288
  s_mov_b32 m0, s55
  s_nop 0
  buffer_load_dwordx4 v224, s[8:11], s61 offen lds
  s_add_u32 s55, s58, 13312
  s_mov_b32 m0, s55
  s_nop 0
  buffer_load_dwordx4 v225, s[8:11], s61 offen lds
  s_add_u32 s55, s58, 14336
  s_mov_b32 m0, s55
  s_nop 0
  buffer_load_dwordx4 v226, s[8:11], s61 offen lds
  s_add_u32 s55, s58, 15360
  s_mov_b32 m0, s55
  s_nop 0
  buffer_load_dwordx4 v227, s[8:11], s61 offen lds
  s_waitcnt vmcnt(8)
  ds_read_b128 v[64:67], v212 offset:0
  ds_read_b128 v[68:71], v214 offset:0
  ds_read_b128 v[72:75], v216 offset:0
  ds_read_b128 v[76:79], v218 offset:0
  ds_read_b128 v[80:83], v213 offset:0
  ds_read_b128 v[84:87], v215 offset:0
  ds_read_b128 v[88:91], v217 offset:0
  ds_read_b128 v[92:95], v219 offset:0
  s_waitcnt lgkmcnt(0)
  s_waitcnt vmcnt(0)
  ds_read_b128 v[96:99], v212 offset:8192
  ds_read_b128 v[100:103], v214 offset:8192
  ds_read_b128 v[104:107], v216 offset:8192
  ds_read_b128 v[108:111], v218 offset:8192
  ds_read_b128 v[112:115], v213 offset:8192
  ds_read_b128 v[116:119], v215 offset:8192
  ds_read_b128 v[120:123], v217 offset:8192
  ds_read_b128 v[124:127], v219 offset:8192
  s_waitcnt lgkmcnt(0)
  s_barrier
  s_add_u32 s57, s57, 1
  s_min_u32 s54, s57, 79
  s_cmp_lt_u32 s54, 24
  s_cbranch_scc0 L_k1_gu1
  s_mov_b32 s28, s12
  s_mov_b32 s32, s12
  s_mov_b32 s29, s13
  s_mov_b32 s33, s13
  s_mov_b32 s30, s14
  s_mov_b32 s34, s14
  s_mov_b32 s31, s15
  s_mov_b32 s35, s15
  s_lshl_b32 s36, s54, 7
  s_add_u32 s37, s36, 64
  s_mov_b32 s38, 196608
  v_mov_b32 v177, v178
  s_branch L_k1_sd1
L_k1_gu1:
  s_nop 7
  s_nop 4
  s_mov_b32 s28, s16
  s_mov_b32 s32, s20
  s_mov_b32 s29, s17
  s_mov_b32 s33, s21
  s_mov_b32 s30, s18
  s_mov_b32 s34, s22
  s_mov_b32 s31, s19
  s_mov_b32 s35, s23
  s_sub_u32 s36, s54, 24
  s_lshl_b32 s36, s36, 6
  s_mov_b32 s37, s36
  s_mov_b32 s38, 229376
  v_mov_b32 v177, v179
L_k1_sd1:
  s_nop 7
  s_nop 4
  s_xor_b32 s62, s62, 0x10000
  s_add_u32 s55, s62, 0
  s_mov_b32 m0, s55
  s_nop 0
  buffer_load_dwordx4 v177, s[28:31], s36 offen lds
  s_add_u32 s55, s62, 4096
  s_mov_b32 m0, s55
  s_nop 0
  buffer_load_dwordx4 v177, s[32:35], s37 offen lds
  s_add_u32 s36, s36, s38
  s_add_u32 s37, s37, s38
  s_add_u32 s55, s62, 8192
  s_mov_b32 m0, s55
  s_nop 0
  buffer_load_dwordx4 v177, s[28:31], s36 offen lds
  s_add_u32 s55, s62, 12288
  s_mov_b32 m0, s55
  s_nop 0
  buffer_load_dwordx4 v177, s[32:35], s37 offen lds
  s_add_u32 s36, s36, s38
  s_add_u32 s37, s37, s38
  s_add_u32 s55, s62, 16384
  s_mov_b32 m0, s55
  s_nop 0
  buffer_load_dwordx4 v177, s[28:31], s36 offen lds
  s_add_u32 s55, s62, 20480
  s_mov_b32 m0, s55
  s_nop 0
  buffer_load_dwordx4 v177, s[32:35], s37 offen lds
  s_add_u32 s36, s36, s38
  s_add_u32 s37, s37, s38
  s_add_u32 s55, s62, 24576
  s_mov_b32 m0, s55
  s_nop 0
  buffer_load_dwordx4 v177, s[28:31], s36 offen lds
  s_add_u32 s55, s62, 28672
  s_mov_b32 m0, s55
  s_nop 0
  buffer_load_dwordx4 v177, s[32:35], s37 offen lds
  s_add_u32 s36, s36, s38
  s_add_u32 s37, s37, s38
  s_add_u32 s55, s62, 32768
  s_mov_b32 m0, s55
  s_nop 0
  buffer_load_dwordx4 v177, s[28:31], s36 offen lds
  s_add_u32 s55, s62, 36864
  s_mov_b32 m0, s55
  s_nop 0
  buffer_load_dwordx4 v177, s[32:35], s37 offen lds
  s_add_u32 s36, s36, s38
  s_add_u32 s37, s37, s38
  s_add_u32 s55, s62, 40960
  s_mov_b32 m0, s55
  s_nop 0
  buffer_load_dwordx4 v177, s[28:31], s36 offen lds
  s_add_u32 s55, s62, 45056
  s_mov_b32 m0, s55
  s_nop 0
  buffer_load_dwordx4 v177, s[32:35], s37 offen lds
  s_add_u32 s36, s36, s38
  s_add_u32 s37, s37, s38
  v_xor_b32 v187, 0x10000, v176
  v_mov_b32 v210, 0x3f803f80
  v_mov_b32 v190, 0
  v_mov_b32 v194, 0
  v_mov_b32 v191, 0
  v_mov_b32 v195, 0
  v_mov_b32 v192, 0
  v_mov_b32 v196, 0
  v_mov_b32 v193, 0
  v_mov_b32 v197, 0
  s_nop 1
  v_dot2_f32_bf16 v190, v0, v210, v190
  v_dot2_f32_bf16 v194, v0, v0, v194
  v_dot2_f32_bf16 v191, v1, v210, v191
  v_dot2_f32_bf16 v195, v1, v1, v195
  v_dot2_f32_bf16 v192, v2, v210, v192
  v_dot2_f32_bf16 v196, v2, v2, v196
  v_dot2_f32_bf16 v193, v3, v210, v193
  v_dot2_f32_bf16 v197, v3, v3, v197
  v_dot2_f32_bf16 v190, v4, v210, v190
  v_dot2_f32_bf16 v194, v4, v4, v194
  v_dot2_f32_bf16 v191, v5, v210, v191
  v_dot2_f32_bf16 v195, v5, v5, v195
  v_dot2_f32_bf16 v192, v6, v210, v192
  v_dot2_f32_bf16 v196, v6, v6, v196
  v_dot2_f32_bf16 v193, v7, v210, v193
  v_dot2_f32_bf16 v197, v7, v7, v197
  v_dot2_f32_bf16 v190, v8, v210, v190
  v_dot2_f32_bf16 v194, v8, v8, v194
  v_dot2_f32_bf16 v191, v9, v210, v191
  v_dot2_f32_bf16 v195, v9, v9, v195
  v_dot2_f32_bf16 v192, v10, v210, v192
  v_dot2_f32_bf16 v196, v10, v10, v196
  v_dot2_f32_bf16 v193, v11, v210, v193
  v_dot2_f32_bf16 v197, v11, v11, v197
  v_dot2_f32_bf16 v190, v12, v210, v190
  v_dot2_f32_bf16 v194, v12, v12, v194
  v_dot2_f32_bf16 v191, v13, v210, v191
  v_dot2_f32_bf16 v195, v13, v13, v195
  v_dot2_f32_bf16 v192, v14, v210, v192
  v_dot2_f32_bf16 v196, v14, v14, v196
  v_dot2_f32_bf16 v193, v15, v210, v193
  v_dot2_f32_bf16 v197, v15, v15, v197
  v_dot2_f32_bf16 v190, v16, v210, v190
  v_dot2_f32_bf16 v194, v16, v16, v194
  v_dot2_f32_bf16 v191, v17, v210, v191
  v_dot2_f32_bf16 v195, v17, v17, v195
  v_dot2_f32_bf16 v192, v18, v210, v192
  v_dot2_f32_bf16 v196, v18, v18, v196
  v_dot2_f32_bf16 v193, v19, v210, v193
  v_dot2_f32_bf16 v197, v19, v19, v197
  v_dot2_f32_bf16 v190, v20, v210, v190
  v_dot2_f32_bf16 v194, v20, v20, v194
  v_dot2_f32_bf16 v191, v21, v210, v191
  v_dot2_f32_bf16 v195, v21, v21, v195
  v_dot2_f32_bf16 v192, v22, v210, v192
  v_dot2_f32_bf16 v196, v22, v22, v196
  v_dot2_f32_bf16 v193, v23, v210, v193
  v_dot2_f32_bf16 v197, v23, v23, v197
  v_dot2_f32_bf16 v190, v24, v210, v190
  v_dot2_f32_bf16 v194, v24, v24, v194
  v_dot2_f32_bf16 v191, v25, v210, v191
  v_dot2_f32_bf16 v195, v25, v25, v195
  v_dot2_f32_bf16 v192, v26, v210, v192
  v_dot2_f32_bf16 v196, v26, v26, v196
  v_dot2_f32_bf16 v193, v27, v210, v193
  v_dot2_f32_bf16 v197, v27, v27, v197
  v_dot2_f32_bf16 v190, v28, v210, v190
  v_dot2_f32_bf16 v194, v28, v28, v194
  v_dot2_f32_bf16 v191, v29, v210, v191
  v_dot2_f32_bf16 v195, v29, v29, v195
  v_dot2_f32_bf16 v192, v30, v210, v192
  v_dot2_f32_bf16 v196, v30, v30, v196
  v_dot2_f32_bf16 v193, v31, v210, v193
  v_dot2_f32_bf16 v197, v31, v31, v197
  v_dot2_f32_bf16 v190, v32, v210, v190
  v_dot2_f32_bf16 v194, v32, v32, v194
  v_dot2_f32_bf16 v191, v33, v210, v191
  v_dot2_f32_bf16 v195, v33, v33, v195
  v_dot2_f32_bf16 v192, v34, v210, v192
  v_dot2_f32_bf16 v196, v34, v34, v196
  v_dot2_f32_bf16 v193, v35, v210, v193
  v_dot2_f32_bf16 v197, v35, v35, v197
  v_dot2_f32_bf16 v190, v36, v210, v190
  v_dot2_f32_bf16 v194, v36, v36, v194
  v_dot2_f32_bf16 v191, v37, v210, v191
  v_dot2_f32_bf16 v195, v37, v37, v195
  v_dot2_f32_bf16 v192, v38, v210, v192
  v_dot2_f32_bf16 v196, v38, v38, v196
  v_dot2_f32_bf16 v193, v39, v210, v193
  v_dot2_f32_bf16 v197, v39, v39, v197
  v_dot2_f32_bf16 v190, v40, v210, v190
  v_dot2_f32_bf16 v194, v40, v40, v194
  v_dot2_f32_bf16 v191, v41, v210, v191
  v_dot2_f32_bf16 v195, v41, v41, v195
  v_dot2_f32_bf16 v192, v42, v210, v192
  v_dot2_f32_bf16 v196, v42, v42, v196
  v_dot2_f32_bf16 v193, v43, v210, v193
  v_dot2_f32_bf16 v197, v43, v43, v197
  v_dot2_f32_bf16 v190, v44, v210, v190
  v_dot2_f32_bf16 v194, v44, v44, v194
  v_dot2_f32_bf16 v191, v45, v210, v191
  v_dot2_f32_bf16 v195, v45, v45, v195
  v_dot2_f32_bf16 v192, v46, v210, v192
  v_dot2_f32_bf16 v196, v46, v46, v196
  v_dot2_f32_bf16 v193, v47, v210, v193
  v_dot2_f32_bf16 v197, v47, v47, v197
  v_dot2_f32_bf16 v190, v48, v210, v190
  v_dot2_f32_bf16 v194, v48, v48, v194
  v_dot2_f32_bf16 v191, v49, v210, v191
  v_dot2_f32_bf16 v195, v49, v49, v195
  v_dot2_f32_bf16 v192, v50, v210, v192
  v_dot2_f32_bf16 v196, v50, v50, v196
  v_dot2_f32_bf16 v193, v51, v210, v193
  v_dot2_f32_bf16 v197, v51, v51, v197
  v_dot2_f32_bf16 v190, v52, v210, v190
  v_dot2_f32_bf16 v194, v52, v52, v194
  v_dot2_f32_bf16 v191, v53, v210, v191
  v_dot2_f32_bf16 v195, v53, v53, v195
  v_dot2_f32_bf16 v192, v54, v210, v192
  v_dot2_f32_bf16 v196, v54, v54, v196
  v_dot2_f32_bf16 v193, v55, v210, v193
  v_dot2_f32_bf16 v197, v55, v55, v197
  v_dot2_f32_bf16 v190, v56, v210, v190
  v_dot2_f32_bf16 v194, v56, v56, v194
  v_dot2_f32_bf16 v191, v57, v210, v191
  v_dot2_f32_bf16 v195, v57, v57, v195
  v_dot2_f32_bf16 v192, v58, v210, v192
  v_dot2_f32_bf16 v196, v58, v58, v196
  v_dot2_f32_bf16 v193, v59, v210, v193
  v_dot2_f32_bf16 v197, v59, v59, v197
  v_dot2_f32_bf16 v190, v60, v210, v190
  v_dot2_f32_bf16 v194, v60, v60, v194
  v_dot2_f32_bf16 v191, v61, v210, v191
  v_dot2_f32_bf16 v195, v61, v61, v195
  v_dot2_f32_bf16 v192, v62, v210, v192
  v_dot2_f32_bf16 v196, v62, v62, v196
  v_dot2_f32_bf16 v193, v63, v210, v193
  v_dot2_f32_bf16 v197, v63, v63, v197
  v_dot2_f32_bf16 v190, v64, v210, v190
  v_dot2_f32_bf16 v194, v64, v64, v194
  v_dot2_f32_bf16 v191, v65, v210, v191
  v_dot2_f32_bf16 v195, v65, v65, v195
  v_dot2_f32_bf16 v192, v66, v210, v192
  v_dot2_f32_bf16 v196, v66, v66, v196
  v_dot2_f32_bf16 v193, v67, v210, v193
  v_dot2_f32_bf16 v197, v67, v67, v197
  v_dot2_f32_bf16 v190, v68, v210, v190
  v_dot2_f32_bf16 v194, v68, v68, v194
  v_dot2_f32_bf16 v191, v69, v210, v191
  v_dot2_f32_bf16 v195, v69, v69, v195
  v_dot2_f32_bf16 v192, v70, v210, v192
  v_dot2_f32_bf16 v196, v70, v70, v196
  v_dot2_f32_bf16 v193, v71, v210, v193
  v_dot2_f32_bf16 v197, v71, v71, v197
  v_dot2_f32_bf16 v190, v72, v210, v190
  v_dot2_f32_bf16 v194, v72, v72, v194
  v_dot2_f32_bf16 v191, v73, v210, v191
  v_dot2_f32_bf16 v195, v73, v73, v195
  v_dot2_f32_bf16 v192, v74, v210, v192
  v_dot2_f32_bf16 v196, v74, v74, v196
  v_dot2_f32_bf16 v193, v75, v210, v193
  v_dot2_f32_bf16 v197, v75, v75, v197
  v_dot2_f32_bf16 v190, v76, v210, v190
  v_dot2_f32_bf16 v194, v76, v76, v194
  v_dot2_f32_bf16 v191, v77, v210, v191
  v_dot2_f32_bf16 v195, v77, v77, v195
  v_dot2_f32_bf16 v192, v78, v210, v192
  v_dot2_f32_bf16 v196, v78, v78, v196
  v_dot2_f32_bf16 v193, v79, v210, v193
  v_dot2_f32_bf16 v197, v79, v79, v197
  v_dot2_f32_bf16 v190, v80, v210, v190
  v_dot2_f32_bf16 v194, v80, v80, v194
  v_dot2_f32_bf16 v191, v81, v210, v191
  v_dot2_f32_bf16 v195, v81, v81, v195
  v_dot2_f32_bf16 v192, v82, v210, v192
  v_dot2_f32_bf16 v196, v82, v82, v196
  v_dot2_f32_bf16 v193, v83, v210, v193
  v_dot2_f32_bf16 v197, v83, v83, v197
  v_dot2_f32_bf16 v190, v84, v210, v190
  v_dot2_f32_bf16 v194, v84, v84, v194
  v_dot2_f32_bf16 v191, v85, v210, v191
  v_dot2_f32_bf16 v195, v85, v85, v195
  v_dot2_f32_bf16 v192, v86, v210, v192
  v_dot2_f32_bf16 v196, v86, v86, v196
  v_dot2_f32_bf16 v193, v87, v210, v193
  v_dot2_f32_bf16 v197, v87, v87, v197
  v_dot2_f32_bf16 v190, v88, v210, v190
  v_dot2_f32_bf16 v194, v88, v88, v194
  v_dot2_f32_bf16 v191, v89, v210, v191
  v_dot2_f32_bf16 v195, v89, v89, v195
  v_dot2_f32_bf16 v192, v90, v210, v192
  v_dot2_f32_bf16 v196, v90, v90, v196
  v_dot2_f32_bf16 v193, v91, v210, v193
  v_dot2_f32_bf16 v197, v91, v91, v197
  v_dot2_f32_bf16 v190, v92, v210, v190
  v_dot2_f32_bf16 v194, v92, v92, v194
  v_dot2_f32_bf16 v191, v93, v210, v191
  v_dot2_f32_bf16 v195, v93, v93, v195
  v_dot2_f32_bf16 v192, v94, v210, v192
  v_dot2_f32_bf16 v196, v94, v94, v196
  v_dot2_f32_bf16 v193, v95, v210, v193
  v_dot2_f32_bf16 v197, v95, v95, v197
  v_dot2_f32_bf16 v190, v96, v210, v190
  v_dot2_f32_bf16 v194, v96, v96, v194
  v_dot2_f32_bf16 v191, v97, v210, v191
  v_dot2_f32_bf16 v195, v97, v97, v195
  v_dot2_f32_bf16 v192, v98, v210, v192
  v_dot2_f32_bf16 v196, v98, v98, v196
  v_dot2_f32_bf16 v193, v99, v210, v193
  v_dot2_f32_bf16 v197, v99, v99, v197
  v_dot2_f32_bf16 v190, v100, v210, v190
  v_dot2_f32_bf16 v194, v100, v100, v194
  v_dot2_f32_bf16 v191, v101, v210, v191
  v_dot2_f32_bf16 v195, v101, v101, v195
  v_dot2_f32_bf16 v192, v102, v210, v192
  v_dot2_f32_bf16 v196, v102, v102, v196
  v_dot2_f32_bf16 v193, v103, v210, v193
  v_dot2_f32_bf16 v197, v103, v103, v197
  v_dot2_f32_bf16 v190, v104, v210, v190
  v_dot2_f32_bf16 v194, v104, v104, v194
  v_dot2_f32_bf16 v191, v105, v210, v191
  v_dot2_f32_bf16 v195, v105, v105, v195
  v_dot2_f32_bf16 v192, v106, v210, v192
  v_dot2_f32_bf16 v196, v106, v106, v196
  v_dot2_f32_bf16 v193, v107, v210, v193
  v_dot2_f32_bf16 v197, v107, v107, v197
  v_dot2_f32_bf16 v190, v108, v210, v190
  v_dot2_f32_bf16 v194, v108, v108, v194
  v_dot2_f32_bf16 v191, v109, v210, v191
  v_dot2_f32_bf16 v195, v109, v109, v195
  v_dot2_f32_bf16 v192, v110, v210, v192
  v_dot2_f32_bf16 v196, v110, v110, v196
  v_dot2_f32_bf16 v193, v111, v210, v193
  v_dot2_f32_bf16 v197, v111, v111, v197
  v_dot2_f32_bf16 v190, v112, v210, v190
  v_dot2_f32_bf16 v194, v112, v112, v194
  v_dot2_f32_bf16 v191, v113, v210, v191
  v_dot2_f32_bf16 v195, v113, v113, v195
  v_dot2_f32_bf16 v192, v114, v210, v192
  v_dot2_f32_bf16 v196, v114, v114, v196
  v_dot2_f32_bf16 v193, v115, v210, v193
  v_dot2_f32_bf16 v197, v115, v115, v197
  v_dot2_f32_bf16 v190, v116, v210, v190
  v_dot2_f32_bf16 v194, v116, v116, v194
  v_dot2_f32_bf16 v191, v117, v210, v191
  v_dot2_f32_bf16 v195, v117, v117, v195
  v_dot2_f32_bf16 v192, v118, v210, v192
  v_dot2_f32_bf16 v196, v118, v118, v196
  v_dot2_f32_bf16 v193, v119, v210, v193
  v_dot2_f32_bf16 v197, v119, v119, v197
  v_dot2_f32_bf16 v190, v120, v210, v190
  v_dot2_f32_bf16 v194, v120, v120, v194
  v_dot2_f32_bf16 v191, v121, v210, v191
  v_dot2_f32_bf16 v195, v121, v121, v195
  v_dot2_f32_bf16 v192, v122, v210, v192
  v_dot2_f32_bf16 v196, v122, v122, v196
  v_dot2_f32_bf16 v193, v123, v210, v193
  v_dot2_f32_bf16 v197, v123, v123, v197
  v_dot2_f32_bf16 v190, v124, v210, v190
  v_dot2_f32_bf16 v194, v124, v124, v194
  v_dot2_f32_bf16 v191, v125, v210, v191
  v_dot2_f32_bf16 v195, v125, v125, v195
  v_dot2_f32_bf16 v192, v126, v210, v192
  v_dot2_f32_bf16 v196, v126, v126, v196
  v_dot2_f32_bf16 v193, v127, v210, v193
  v_dot2_f32_bf16 v197, v127, v127, v197
  s_nop 3
  v_add_f32 v190, v190, v191
  v_add_f32 v192, v192, v193
  v_add_f32 v190, v190, v192
  v_add_f32 v194, v194, v195
  v_add_f32 v196, v196, v197
  v_add_f32 v194, v194, v196
  v_mov_b32 v191, v190
  v_mov_b32 v195, v194
  s_nop 0
  v_permlane32_swap_b32 v190, v191
  v_permlane32_swap_b32 v194, v195
  v_add_f32 v190, v190, v191
  v_add_f32 v194, v194, v195
  v_mul_f32 v190, 0x3b000000, v190
  v_mul_f32 v194, 0x3b000000, v194
  v_fma_f32 v194, -v190, v190, v194
  v_add_f32 v194, 0x3727c5ac, v194
  v_rsq_f32 v194, v194
  s_nop 0
  v_mul_f32 v195, v190, v194
  v_sub_f32 v195, 0, v195
  v_mov_b32 v211, 0xffff0000
  v_lshlrev_b32 v198, 16, v0
  v_and_b32 v199, v211, v0
  v_fma_f32 v198, v198, v194, v195
  v_fma_f32 v199, v199, v194, v195
  v_cvt_pk_bf16_f32 v0, v198, v199
  v_lshlrev_b32 v200, 16, v1
  v_and_b32 v201, v211, v1
  v_fma_f32 v200, v200, v194, v195
  v_fma_f32 v201, v201, v194, v195
  v_cvt_pk_bf16_f32 v1, v200, v201
  v_lshlrev_b32 v202, 16, v2
  v_and_b32 v203, v211, v2
  v_fma_f32 v202, v202, v194, v195
  v_fma_f32 v203, v203, v194, v195
  v_cvt_pk_bf16_f32 v2, v202, v203
  v_lshlrev_b32 v204, 16, v3
  v_and_b32 v205, v211, v3
  v_fma_f32 v204, v204, v194, v195
  v_fma_f32 v205, v205, v194, v195
  v_cvt_pk_bf16_f32 v3, v204, v205
  v_lshlrev_b32 v198, 16, v4
  v_and_b32 v199, v211, v4
  v_fma_f32 v198, v198, v194, v195
  v_fma_f32 v199, v199, v194, v195
  v_cvt_pk_bf16_f32 v4, v198, v199
  v_lshlrev_b32 v200, 16, v5
  v_and_b32 v201, v211, v5
  v_fma_f32 v200, v200, v194, v195
  v_fma_f32 v201, v201, v194, v195
  v_cvt_pk_bf16_f32 v5, v200, v201
  v_lshlrev_b32 v202, 16, v6
  v_and_b32 v203, v211, v6
  v_fma_f32 v202, v202, v194, v195
  v_fma_f32 v203, v203, v194, v195
  v_cvt_pk_bf16_f32 v6, v202, v203
  v_lshlrev_b32 v204, 16, v7
  v_and_b32 v205, v211, v7
  v_fma_f32 v204, v204, v194, v195
  v_fma_f32 v205, v205, v194, v195
  v_cvt_pk_bf16_f32 v7, v204, v205
  v_lshlrev_b32 v198, 16, v8
  v_and_b32 v199, v211, v8
  v_fma_f32 v198, v198, v194, v195
  v_fma_f32 v199, v199, v194, v195
  v_cvt_pk_bf16_f32 v8, v198, v199
  v_lshlrev_b32 v200, 16, v9
  v_and_b32 v201, v211, v9
  v_fma_f32 v200, v200, v194, v195
  v_fma_f32 v201, v201, v194, v195
  v_cvt_pk_bf16_f32 v9, v200, v201
  v_lshlrev_b32 v202, 16, v10
  v_and_b32 v203, v211, v10
  v_fma_f32 v202, v202, v194, v195
  v_fma_f32 v203, v203, v194, v195
  v_cvt_pk_bf16_f32 v10, v202, v203
  v_lshlrev_b32 v204, 16, v11
  v_and_b32 v205, v211, v11
  v_fma_f32 v204, v204, v194, v195
  v_fma_f32 v205, v205, v194, v195
  v_cvt_pk_bf16_f32 v11, v204, v205
  v_lshlrev_b32 v198, 16, v12
  v_and_b32 v199, v211, v12
  v_fma_f32 v198, v198, v194, v195
  v_fma_f32 v199, v199, v194, v195
  v_cvt_pk_bf16_f32 v12, v198, v199
  v_lshlrev_b32 v200, 16, v13
  v_and_b32 v201, v211, v13
  v_fma_f32 v200, v200, v194, v195
  v_fma_f32 v201, v201, v194, v195
  v_cvt_pk_bf16_f32 v13, v200, v201
  v_lshlrev_b32 v202, 16, v14
  v_and_b32 v203, v211, v14
  v_fma_f32 v202, v202, v194, v195
  v_fma_f32 v203, v203, v194, v195
  v_cvt_pk_bf16_f32 v14, v202, v203
  v_lshlrev_b32 v204, 16, v15
  v_and_b32 v205, v211, v15
  v_fma_f32 v204, v204, v194, v195
  v_fma_f32 v205, v205, v194, v195
  v_cvt_pk_bf16_f32 v15, v204, v205
  v_lshlrev_b32 v198, 16, v16
  v_and_b32 v199, v211, v16
  v_fma_f32 v198, v198, v194, v195
  v_fma_f32 v199, v199, v194, v195
  v_cvt_pk_bf16_f32 v16, v198, v199
  v_lshlrev_b32 v200, 16, v17
  v_and_b32 v201, v211, v17
  v_fma_f32 v200, v200, v194, v195
  v_fma_f32 v201, v201, v194, v195
  v_cvt_pk_bf16_f32 v17, v200, v201
  v_lshlrev_b32 v202, 16, v18
  v_and_b32 v203, v211, v18
  v_fma_f32 v202, v202, v194, v195
  v_fma_f32 v203, v203, v194, v195
  v_cvt_pk_bf16_f32 v18, v202, v203
  v_lshlrev_b32 v204, 16, v19
  v_and_b32 v205, v211, v19
  v_fma_f32 v204, v204, v194, v195
  v_fma_f32 v205, v205, v194, v195
  v_cvt_pk_bf16_f32 v19, v204, v205
  v_lshlrev_b32 v198, 16, v20
  v_and_b32 v199, v211, v20
  v_fma_f32 v198, v198, v194, v195
  v_fma_f32 v199, v199, v194, v195
  v_cvt_pk_bf16_f32 v20, v198, v199
  v_lshlrev_b32 v200, 16, v21
  v_and_b32 v201, v211, v21
  v_fma_f32 v200, v200, v194, v195
  v_fma_f32 v201, v201, v194, v195
  v_cvt_pk_bf16_f32 v21, v200, v201
  v_lshlrev_b32 v202, 16, v22
  v_and_b32 v203, v211, v22
  v_fma_f32 v202, v202, v194, v195
  v_fma_f32 v203, v203, v194, v195
  v_cvt_pk_bf16_f32 v22, v202, v203
  v_lshlrev_b32 v204, 16, v23
  v_and_b32 v205, v211, v23
  v_fma_f32 v204, v204, v194, v195
  v_fma_f32 v205, v205, v194, v195
  v_cvt_pk_bf16_f32 v23, v204, v205
  v_lshlrev_b32 v198, 16, v24
  v_and_b32 v199, v211, v24
  v_fma_f32 v198, v198, v194, v195
  v_fma_f32 v199, v199, v194, v195
  v_cvt_pk_bf16_f32 v24, v198, v199
  v_lshlrev_b32 v200, 16, v25
  v_and_b32 v201, v211, v25
  v_fma_f32 v200, v200, v194, v195
  v_fma_f32 v201, v201, v194, v195
  v_cvt_pk_bf16_f32 v25, v200, v201
  v_lshlrev_b32 v202, 16, v26
  v_and_b32 v203, v211, v26
  v_fma_f32 v202, v202, v194, v195
  v_fma_f32 v203, v203, v194, v195
  v_cvt_pk_bf16_f32 v26, v202, v203
  v_lshlrev_b32 v204, 16, v27
  v_and_b32 v205, v211, v27
  v_fma_f32 v204, v204, v194, v195
  v_fma_f32 v205, v205, v194, v195
  v_cvt_pk_bf16_f32 v27, v204, v205
  v_lshlrev_b32 v198, 16, v28
  v_and_b32 v199, v211, v28
  v_fma_f32 v198, v198, v194, v195
  v_fma_f32 v199, v199, v194, v195
  v_cvt_pk_bf16_f32 v28, v198, v199
  v_lshlrev_b32 v200, 16, v29
  v_and_b32 v201, v211, v29
  v_fma_f32 v200, v200, v194, v195
  v_fma_f32 v201, v201, v194, v195
  v_cvt_pk_bf16_f32 v29, v200, v201
  v_lshlrev_b32 v202, 16, v30
  v_and_b32 v203, v211, v30
  v_fma_f32 v202, v202, v194, v195
  v_fma_f32 v203, v203, v194, v195
  v_cvt_pk_bf16_f32 v30, v202, v203
  v_lshlrev_b32 v204, 16, v31
  v_and_b32 v205, v211, v31
  v_fma_f32 v204, v204, v194, v195
  v_fma_f32 v205, v205, v194, v195
  v_cvt_pk_bf16_f32 v31, v204, v205
  v_lshlrev_b32 v198, 16, v32
  v_and_b32 v199, v211, v32
  v_fma_f32 v198, v198, v194, v195
  v_fma_f32 v199, v199, v194, v195
  v_cvt_pk_bf16_f32 v32, v198, v199
  v_lshlrev_b32 v200, 16, v33
  v_and_b32 v201, v211, v33
  v_fma_f32 v200, v200, v194, v195
  v_fma_f32 v201, v201, v194, v195
  v_cvt_pk_bf16_f32 v33, v200, v201
  v_lshlrev_b32 v202, 16, v34
  v_and_b32 v203, v211, v34
  v_fma_f32 v202, v202, v194, v195
  v_fma_f32 v203, v203, v194, v195
  v_cvt_pk_bf16_f32 v34, v202, v203
  v_lshlrev_b32 v204, 16, v35
  v_and_b32 v205, v211, v35
  v_fma_f32 v204, v204, v194, v195
  v_fma_f32 v205, v205, v194, v195
  v_cvt_pk_bf16_f32 v35, v204, v205
  v_lshlrev_b32 v198, 16, v36
  v_and_b32 v199, v211, v36
  v_fma_f32 v198, v198, v194, v195
  v_fma_f32 v199, v199, v194, v195
  v_cvt_pk_bf16_f32 v36, v198, v199
  v_lshlrev_b32 v200, 16, v37
  v_and_b32 v201, v211, v37
  v_fma_f32 v200, v200, v194, v195
  v_fma_f32 v201, v201, v194, v195
  v_cvt_pk_bf16_f32 v37, v200, v201
  v_lshlrev_b32 v202, 16, v38
  v_and_b32 v203, v211, v38
  v_fma_f32 v202, v202, v194, v195
  v_fma_f32 v203, v203, v194, v195
  v_cvt_pk_bf16_f32 v38, v202, v203
  v_lshlrev_b32 v204, 16, v39
  v_and_b32 v205, v211, v39
  v_fma_f32 v204, v204, v194, v195
  v_fma_f32 v205, v205, v194, v195
  v_cvt_pk_bf16_f32 v39, v204, v205
  v_lshlrev_b32 v198, 16, v40
  v_and_b32 v199, v211, v40
  v_fma_f32 v198, v198, v194, v195
  v_fma_f32 v199, v199, v194, v195
  v_cvt_pk_bf16_f32 v40, v198, v199
  v_lshlrev_b32 v200, 16, v41
  v_and_b32 v201, v211, v41
  v_fma_f32 v200, v200, v194, v195
  v_fma_f32 v201, v201, v194, v195
  v_cvt_pk_bf16_f32 v41, v200, v201
  v_lshlrev_b32 v202, 16, v42
  v_and_b32 v203, v211, v42
  v_fma_f32 v202, v202, v194, v195
  v_fma_f32 v203, v203, v194, v195
  v_cvt_pk_bf16_f32 v42, v202, v203
  v_lshlrev_b32 v204, 16, v43
  v_and_b32 v205, v211, v43
  v_fma_f32 v204, v204, v194, v195
  v_fma_f32 v205, v205, v194, v195
  v_cvt_pk_bf16_f32 v43, v204, v205
  v_lshlrev_b32 v198, 16, v44
  v_and_b32 v199, v211, v44
  v_fma_f32 v198, v198, v194, v195
  v_fma_f32 v199, v199, v194, v195
  v_cvt_pk_bf16_f32 v44, v198, v199
  v_lshlrev_b32 v200, 16, v45
  v_and_b32 v201, v211, v45
  v_fma_f32 v200, v200, v194, v195
  v_fma_f32 v201, v201, v194, v195
  v_cvt_pk_bf16_f32 v45, v200, v201
  v_lshlrev_b32 v202, 16, v46
  v_and_b32 v203, v211, v46
  v_fma_f32 v202, v202, v194, v195
  v_fma_f32 v203, v203, v194, v195
  v_cvt_pk_bf16_f32 v46, v202, v203
  v_lshlrev_b32 v204, 16, v47
  v_and_b32 v205, v211, v47
  v_fma_f32 v204, v204, v194, v195
  v_fma_f32 v205, v205, v194, v195
  v_cvt_pk_bf16_f32 v47, v204, v205
  v_lshlrev_b32 v198, 16, v48
  v_and_b32 v199, v211, v48
  v_fma_f32 v198, v198, v194, v195
  v_fma_f32 v199, v199, v194, v195
  v_cvt_pk_bf16_f32 v48, v198, v199
  v_lshlrev_b32 v200, 16, v49
  v_and_b32 v201, v211, v49
  v_fma_f32 v200, v200, v194, v195
  v_fma_f32 v201, v201, v194, v195
  v_cvt_pk_bf16_f32 v49, v200, v201
  v_lshlrev_b32 v202, 16, v50
  v_and_b32 v203, v211, v50
  v_fma_f32 v202, v202, v194, v195
  v_fma_f32 v203, v203, v194, v195
  v_cvt_pk_bf16_f32 v50, v202, v203
  v_lshlrev_b32 v204, 16, v51
  v_and_b32 v205, v211, v51
  v_fma_f32 v204, v204, v194, v195
  v_fma_f32 v205, v205, v194, v195
  v_cvt_pk_bf16_f32 v51, v204, v205
  v_lshlrev_b32 v198, 16, v52
  v_and_b32 v199, v211, v52
  v_fma_f32 v198, v198, v194, v195
  v_fma_f32 v199, v199, v194, v195
  v_cvt_pk_bf16_f32 v52, v198, v199
  v_lshlrev_b32 v200, 16, v53
  v_and_b32 v201, v211, v53
  v_fma_f32 v200, v200, v194, v195
  v_fma_f32 v201, v201, v194, v195
  v_cvt_pk_bf16_f32 v53, v200, v201
  v_lshlrev_b32 v202, 16, v54
  v_and_b32 v203, v211, v54
  v_fma_f32 v202, v202, v194, v195
  v_fma_f32 v203, v203, v194, v195
  v_cvt_pk_bf16_f32 v54, v202, v203
  v_lshlrev_b32 v204, 16, v55
  v_and_b32 v205, v211, v55
  v_fma_f32 v204, v204, v194, v195
  v_fma_f32 v205, v205, v194, v195
  v_cvt_pk_bf16_f32 v55, v204, v205
  v_lshlrev_b32 v198, 16, v56
  v_and_b32 v199, v211, v56
  v_fma_f32 v198, v198, v194, v195
  v_fma_f32 v199, v199, v194, v195
  v_cvt_pk_bf16_f32 v56, v198, v199
  v_lshlrev_b32 v200, 16, v57
  v_and_b32 v201, v211, v57
  v_fma_f32 v200, v200, v194, v195
  v_fma_f32 v201, v201, v194, v195
  v_cvt_pk_bf16_f32 v57, v200, v201
  v_lshlrev_b32 v202, 16, v58
  v_and_b32 v203, v211, v58
  v_fma_f32 v202, v202, v194, v195
  v_fma_f32 v203, v203, v194, v195
  v_cvt_pk_bf16_f32 v58, v202, v203
  v_lshlrev_b32 v204, 16, v59
  v_and_b32 v205, v211, v59
  v_fma_f32 v204, v204, v194, v195
  v_fma_f32 v205, v205, v194, v195
  v_cvt_pk_bf16_f32 v59, v204, v205
  v_lshlrev_b32 v198, 16, v60
  v_and_b32 v199, v211, v60
  v_fma_f32 v198, v198, v194, v195
  v_fma_f32 v199, v199, v194, v195
  v_cvt_pk_bf16_f32 v60, v198, v199
  v_lshlrev_b32 v200, 16, v61
  v_and_b32 v201, v211, v61
  v_fma_f32 v200, v200, v194, v195
  v_fma_f32 v201, v201, v194, v195
  v_cvt_pk_bf16_f32 v61, v200, v201
  v_lshlrev_b32 v202, 16, v62
  v_and_b32 v203, v211, v62
  v_fma_f32 v202, v202, v194, v195
  v_fma_f32 v203, v203, v194, v195
  v_cvt_pk_bf16_f32 v62, v202, v203
  v_lshlrev_b32 v204, 16, v63
  v_and_b32 v205, v211, v63
  v_fma_f32 v204, v204, v194, v195
  v_fma_f32 v205, v205, v194, v195
  v_cvt_pk_bf16_f32 v63, v204, v205
  v_lshlrev_b32 v198, 16, v64
  v_and_b32 v199, v211, v64
  v_fma_f32 v198, v198, v194, v195
  v_fma_f32 v199, v199, v194, v195
  v_cvt_pk_bf16_f32 v64, v198, v199
  v_lshlrev_b32 v200, 16, v65
  v_and_b32 v201, v211, v65
  v_fma_f32 v200, v200, v194, v195
  v_fma_f32 v201, v201, v194, v195
  v_cvt_pk_bf16_f32 v65, v200, v201
  v_lshlrev_b32 v202, 16, v66
  v_and_b32 v203, v211, v66
  v_fma_f32 v202, v202, v194, v195
  v_fma_f32 v203, v203, v194, v195
  v_cvt_pk_bf16_f32 v66, v202, v203
  v_lshlrev_b32 v204, 16, v67
  v_and_b32 v205, v211, v67
  v_fma_f32 v204, v204, v194, v195
  v_fma_f32 v205, v205, v194, v195
  v_cvt_pk_bf16_f32 v67, v204, v205
  v_lshlrev_b32 v198, 16, v68
  v_and_b32 v199, v211, v68
  v_fma_f32 v198, v198, v194, v195
  v_fma_f32 v199, v199, v194, v195
  v_cvt_pk_bf16_f32 v68, v198, v199
  v_lshlrev_b32 v200, 16, v69
  v_and_b32 v201, v211, v69
  v_fma_f32 v200, v200, v194, v195
  v_fma_f32 v201, v201, v194, v195
  v_cvt_pk_bf16_f32 v69, v200, v201
  v_lshlrev_b32 v202, 16, v70
  v_and_b32 v203, v211, v70
  v_fma_f32 v202, v202, v194, v195
  v_fma_f32 v203, v203, v194, v195
  v_cvt_pk_bf16_f32 v70, v202, v203
  v_lshlrev_b32 v204, 16, v71
  v_and_b32 v205, v211, v71
  v_fma_f32 v204, v204, v194, v195
  v_fma_f32 v205, v205, v194, v195
  v_cvt_pk_bf16_f32 v71, v204, v205
  v_lshlrev_b32 v198, 16, v72
  v_and_b32 v199, v211, v72
  v_fma_f32 v198, v198, v194, v195
  v_fma_f32 v199, v199, v194, v195
  v_cvt_pk_bf16_f32 v72, v198, v199
  v_lshlrev_b32 v200, 16, v73
  v_and_b32 v201, v211, v73
  v_fma_f32 v200, v200, v194, v195
  v_fma_f32 v201, v201, v194, v195
  v_cvt_pk_bf16_f32 v73, v200, v201
  v_lshlrev_b32 v202, 16, v74
  v_and_b32 v203, v211, v74
  v_fma_f32 v202, v202, v194, v195
  v_fma_f32 v203, v203, v194, v195
  v_cvt_pk_bf16_f32 v74, v202, v203
  v_lshlrev_b32 v204, 16, v75
  v_and_b32 v205, v211, v75
  v_fma_f32 v204, v204, v194, v195
  v_fma_f32 v205, v205, v194, v195
  v_cvt_pk_bf16_f32 v75, v204, v205
  v_lshlrev_b32 v198, 16, v76
  v_and_b32 v199, v211, v76
  v_fma_f32 v198, v198, v194, v195
  v_fma_f32 v199, v199, v194, v195
  v_cvt_pk_bf16_f32 v76, v198, v199
  v_lshlrev_b32 v200, 16, v77
  v_and_b32 v201, v211, v77
  v_fma_f32 v200, v200, v194, v195
  v_fma_f32 v201, v201, v194, v195
  v_cvt_pk_bf16_f32 v77, v200, v201
  v_lshlrev_b32 v202, 16, v78
  v_and_b32 v203, v211, v78
  v_fma_f32 v202, v202, v194, v195
  v_fma_f32 v203, v203, v194, v195
  v_cvt_pk_bf16_f32 v78, v202, v203
  v_lshlrev_b32 v204, 16, v79
  v_and_b32 v205, v211, v79
  v_fma_f32 v204, v204, v194, v195
  v_fma_f32 v205, v205, v194, v195
  v_cvt_pk_bf16_f32 v79, v204, v205
  v_lshlrev_b32 v198, 16, v80
  v_and_b32 v199, v211, v80
  v_fma_f32 v198, v198, v194, v195
  v_fma_f32 v199, v199, v194, v195
  v_cvt_pk_bf16_f32 v80, v198, v199
  v_lshlrev_b32 v200, 16, v81
  v_and_b32 v201, v211, v81
  v_fma_f32 v200, v200, v194, v195
  v_fma_f32 v201, v201, v194, v195
  v_cvt_pk_bf16_f32 v81, v200, v201
  v_lshlrev_b32 v202, 16, v82
  v_and_b32 v203, v211, v82
  v_fma_f32 v202, v202, v194, v195
  v_fma_f32 v203, v203, v194, v195
  v_cvt_pk_bf16_f32 v82, v202, v203
  v_lshlrev_b32 v204, 16, v83
  v_and_b32 v205, v211, v83
  v_fma_f32 v204, v204, v194, v195
  v_fma_f32 v205, v205, v194, v195
  v_cvt_pk_bf16_f32 v83, v204, v205
  v_lshlrev_b32 v198, 16, v84
  v_and_b32 v199, v211, v84
  v_fma_f32 v198, v198, v194, v195
  v_fma_f32 v199, v199, v194, v195
  v_cvt_pk_bf16_f32 v84, v198, v199
  v_lshlrev_b32 v200, 16, v85
  v_and_b32 v201, v211, v85
  v_fma_f32 v200, v200, v194, v195
  v_fma_f32 v201, v201, v194, v195
  v_cvt_pk_bf16_f32 v85, v200, v201
  v_lshlrev_b32 v202, 16, v86
  v_and_b32 v203, v211, v86
  v_fma_f32 v202, v202, v194, v195
  v_fma_f32 v203, v203, v194, v195
  v_cvt_pk_bf16_f32 v86, v202, v203
  v_lshlrev_b32 v204, 16, v87
  v_and_b32 v205, v211, v87
  v_fma_f32 v204, v204, v194, v195
  v_fma_f32 v205, v205, v194, v195
  v_cvt_pk_bf16_f32 v87, v204, v205
  v_lshlrev_b32 v198, 16, v88
  v_and_b32 v199, v211, v88
  v_fma_f32 v198, v198, v194, v195
  v_fma_f32 v199, v199, v194, v195
  v_cvt_pk_bf16_f32 v88, v198, v199
  v_lshlrev_b32 v200, 16, v89
  v_and_b32 v201, v211, v89
  v_fma_f32 v200, v200, v194, v195
  v_fma_f32 v201, v201, v194, v195
  v_cvt_pk_bf16_f32 v89, v200, v201
  v_lshlrev_b32 v202, 16, v90
  v_and_b32 v203, v211, v90
  v_fma_f32 v202, v202, v194, v195
  v_fma_f32 v203, v203, v194, v195
  v_cvt_pk_bf16_f32 v90, v202, v203
  v_lshlrev_b32 v204, 16, v91
  v_and_b32 v205, v211, v91
  v_fma_f32 v204, v204, v194, v195
  v_fma_f32 v205, v205, v194, v195
  v_cvt_pk_bf16_f32 v91, v204, v205
  v_lshlrev_b32 v198, 16, v92
  v_and_b32 v199, v211, v92
  v_fma_f32 v198, v198, v194, v195
  v_fma_f32 v199, v199, v194, v195
  v_cvt_pk_bf16_f32 v92, v198, v199
  v_lshlrev_b32 v200, 16, v93
  v_and_b32 v201, v211, v93
  v_fma_f32 v200, v200, v194, v195
  v_fma_f32 v201, v201, v194, v195
  v_cvt_pk_bf16_f32 v93, v200, v201
  v_lshlrev_b32 v202, 16, v94
  v_and_b32 v203, v211, v94
  v_fma_f32 v202, v202, v194, v195
  v_fma_f32 v203, v203, v194, v195
  v_cvt_pk_bf16_f32 v94, v202, v203
  v_lshlrev_b32 v204, 16, v95
  v_and_b32 v205, v211, v95
  v_fma_f32 v204, v204, v194, v195
  v_fma_f32 v205, v205, v194, v195
  v_cvt_pk_bf16_f32 v95, v204, v205
  v_lshlrev_b32 v198, 16, v96
  v_and_b32 v199, v211, v96
  v_fma_f32 v198, v198, v194, v195
  v_fma_f32 v199, v199, v194, v195
  v_cvt_pk_bf16_f32 v96, v198, v199
  v_lshlrev_b32 v200, 16, v97
  v_and_b32 v201, v211, v97
  v_fma_f32 v200, v200, v194, v195
  v_fma_f32 v201, v201, v194, v195
  v_cvt_pk_bf16_f32 v97, v200, v201
  v_lshlrev_b32 v202, 16, v98
  v_and_b32 v203, v211, v98
  v_fma_f32 v202, v202, v194, v195
  v_fma_f32 v203, v203, v194, v195
  v_cvt_pk_bf16_f32 v98, v202, v203
  v_lshlrev_b32 v204, 16, v99
  v_and_b32 v205, v211, v99
  v_fma_f32 v204, v204, v194, v195
  v_fma_f32 v205, v205, v194, v195
  v_cvt_pk_bf16_f32 v99, v204, v205
  v_lshlrev_b32 v198, 16, v100
  v_and_b32 v199, v211, v100
  v_fma_f32 v198, v198, v194, v195
  v_fma_f32 v199, v199, v194, v195
  v_cvt_pk_bf16_f32 v100, v198, v199
  v_lshlrev_b32 v200, 16, v101
  v_and_b32 v201, v211, v101
  v_fma_f32 v200, v200, v194, v195
  v_fma_f32 v201, v201, v194, v195
  v_cvt_pk_bf16_f32 v101, v200, v201
  v_lshlrev_b32 v202, 16, v102
  v_and_b32 v203, v211, v102
  v_fma_f32 v202, v202, v194, v195
  v_fma_f32 v203, v203, v194, v195
  v_cvt_pk_bf16_f32 v102, v202, v203
  v_lshlrev_b32 v204, 16, v103
  v_and_b32 v205, v211, v103
  v_fma_f32 v204, v204, v194, v195
  v_fma_f32 v205, v205, v194, v195
  v_cvt_pk_bf16_f32 v103, v204, v205
  v_lshlrev_b32 v198, 16, v104
  v_and_b32 v199, v211, v104
  v_fma_f32 v198, v198, v194, v195
  v_fma_f32 v199, v199, v194, v195
  v_cvt_pk_bf16_f32 v104, v198, v199
  v_lshlrev_b32 v200, 16, v105
  v_and_b32 v201, v211, v105
  v_fma_f32 v200, v200, v194, v195
  v_fma_f32 v201, v201, v194, v195
  v_cvt_pk_bf16_f32 v105, v200, v201
  v_lshlrev_b32 v202, 16, v106
  v_and_b32 v203, v211, v106
  v_fma_f32 v202, v202, v194, v195
  v_fma_f32 v203, v203, v194, v195
  v_cvt_pk_bf16_f32 v106, v202, v203
  v_lshlrev_b32 v204, 16, v107
  v_and_b32 v205, v211, v107
  v_fma_f32 v204, v204, v194, v195
  v_fma_f32 v205, v205, v194, v195
  v_cvt_pk_bf16_f32 v107, v204, v205
  v_lshlrev_b32 v198, 16, v108
  v_and_b32 v199, v211, v108
  v_fma_f32 v198, v198, v194, v195
  v_fma_f32 v199, v199, v194, v195
  v_cvt_pk_bf16_f32 v108, v198, v199
  v_lshlrev_b32 v200, 16, v109
  v_and_b32 v201, v211, v109
  v_fma_f32 v200, v200, v194, v195
  v_fma_f32 v201, v201, v194, v195
  v_cvt_pk_bf16_f32 v109, v200, v201
  v_lshlrev_b32 v202, 16, v110
  v_and_b32 v203, v211, v110
  v_fma_f32 v202, v202, v194, v195
  v_fma_f32 v203, v203, v194, v195
  v_cvt_pk_bf16_f32 v110, v202, v203
  v_lshlrev_b32 v204, 16, v111
  v_and_b32 v205, v211, v111
  v_fma_f32 v204, v204, v194, v195
  v_fma_f32 v205, v205, v194, v195
  v_cvt_pk_bf16_f32 v111, v204, v205
  v_lshlrev_b32 v198, 16, v112
  v_and_b32 v199, v211, v112
  v_fma_f32 v198, v198, v194, v195
  v_fma_f32 v199, v199, v194, v195
  v_cvt_pk_bf16_f32 v112, v198, v199
  v_lshlrev_b32 v200, 16, v113
  v_and_b32 v201, v211, v113
  v_fma_f32 v200, v200, v194, v195
  v_fma_f32 v201, v201, v194, v195
  v_cvt_pk_bf16_f32 v113, v200, v201
  v_lshlrev_b32 v202, 16, v114
  v_and_b32 v203, v211, v114
  v_fma_f32 v202, v202, v194, v195
  v_fma_f32 v203, v203, v194, v195
  v_cvt_pk_bf16_f32 v114, v202, v203
  v_lshlrev_b32 v204, 16, v115
  v_and_b32 v205, v211, v115
  v_fma_f32 v204, v204, v194, v195
  v_fma_f32 v205, v205, v194, v195
  v_cvt_pk_bf16_f32 v115, v204, v205
  v_lshlrev_b32 v198, 16, v116
  v_and_b32 v199, v211, v116
  v_fma_f32 v198, v198, v194, v195
  v_fma_f32 v199, v199, v194, v195
  v_cvt_pk_bf16_f32 v116, v198, v199
  v_lshlrev_b32 v200, 16, v117
  v_and_b32 v201, v211, v117
  v_fma_f32 v200, v200, v194, v195
  v_fma_f32 v201, v201, v194, v195
  v_cvt_pk_bf16_f32 v117, v200, v201
  v_lshlrev_b32 v202, 16, v118
  v_and_b32 v203, v211, v118
  v_fma_f32 v202, v202, v194, v195
  v_fma_f32 v203, v203, v194, v195
  v_cvt_pk_bf16_f32 v118, v202, v203
  v_lshlrev_b32 v204, 16, v119
  v_and_b32 v205, v211, v119
  v_fma_f32 v204, v204, v194, v195
  v_fma_f32 v205, v205, v194, v195
  v_cvt_pk_bf16_f32 v119, v204, v205
  v_lshlrev_b32 v198, 16, v120
  v_and_b32 v199, v211, v120
  v_fma_f32 v198, v198, v194, v195
  v_fma_f32 v199, v199, v194, v195
  v_cvt_pk_bf16_f32 v120, v198, v199
  v_lshlrev_b32 v200, 16, v121
  v_and_b32 v201, v211, v121
  v_fma_f32 v200, v200, v194, v195
  v_fma_f32 v201, v201, v194, v195
  v_cvt_pk_bf16_f32 v121, v200, v201
  v_lshlrev_b32 v202, 16, v122
  v_and_b32 v203, v211, v122
  v_fma_f32 v202, v202, v194, v195
  v_fma_f32 v203, v203, v194, v195
  v_cvt_pk_bf16_f32 v122, v202, v203
  v_lshlrev_b32 v204, 16, v123
  v_and_b32 v205, v211, v123
  v_fma_f32 v204, v204, v194, v195
  v_fma_f32 v205, v205, v194, v195
  v_cvt_pk_bf16_f32 v123, v204, v205
  v_lshlrev_b32 v198, 16, v124
  v_and_b32 v199, v211, v124
  v_fma_f32 v198, v198, v194, v195
  v_fma_f32 v199, v199, v194, v195
  v_cvt_pk_bf16_f32 v124, v198, v199
  v_lshlrev_b32 v200, 16, v125
  v_and_b32 v201, v211, v125
  v_fma_f32 v200, v200, v194, v195
  v_fma_f32 v201, v201, v194, v195
  v_cvt_pk_bf16_f32 v125, v200, v201
  v_lshlrev_b32 v202, 16, v126
  v_and_b32 v203, v211, v126
  v_fma_f32 v202, v202, v194, v195
  v_fma_f32 v203, v203, v194, v195
  v_cvt_pk_bf16_f32 v126, v202, v203
  v_lshlrev_b32 v204, 16, v127
  v_and_b32 v205, v211, v127
  v_fma_f32 v204, v204, v194, v195
  v_fma_f32 v205, v205, v194, v195
  v_cvt_pk_bf16_f32 v127, v204, v205
  s_waitcnt vmcnt(26)
  s_barrier
  ds_read_b64_tr_b16 v[224:225], v176 offset:0
  ds_read_b64_tr_b16 v[226:227], v176 offset:256
  ds_read_b64_tr_b16 v[228:229], v176 offset:4096
  ds_read_b64_tr_b16 v[230:231], v176 offset:4352
  ds_read_b64_tr_b16 v[232:233], v176 offset:512
  ds_read_b64_tr_b16 v[234:235], v176 offset:768
  ds_read_b64_tr_b16 v[236:237], v176 offset:4608
  ds_read_b64_tr_b16 v[238:239], v176 offset:4864
  ds_read_b64_tr_b16 v[240:241], v176 offset:1024
  ds_read_b64_tr_b16 v[242:243], v176 offset:1280
  ds_read_b64_tr_b16 v[244:245], v176 offset:5120
  ds_read_b64_tr_b16 v[246:247], v176 offset:5376
L_k1_tile:
  s_nop 7
  s_nop 4
  s_cmp_ge_u32 s7, 16
  s_cselect_b32 s58, 1, 0
  s_cmp_lt_u32 s7, 24
  s_cselect_b32 s59, 1, 0
  s_and_b32 s58, s58, s59
  s_cmp_eq_u32 s58, 1
  s_cbranch_scc1 L_k1_bodyB
  s_waitcnt vmcnt(24)
  s_barrier
  s_add_u32 s55, s62, 49152
  s_mov_b32 m0, s55
  s_nop 0
  buffer_load_dwordx4 v177, s[28:31], s36 offen lds
  s_add_u32 s55, s62, 53248
  s_mov_b32 m0, s55
  s_nop 0
  buffer_load_dwordx4 v177, s[32:35], s37 offen lds
  s_add_u32 s36, s36, s38
  s_add_u32 s37, s37, s38
  ds_read_b64_tr_b16 v[248:249], v176 offset:1536
  ds_read_b64_tr_b16 v[250:251], v176 offset:1792
  ds_read_b64_tr_b16 v[252:253], v176 offset:5632
  ds_read_b64_tr_b16 v[254:255], v176 offset:5888
  s_waitcnt lgkmcnt(12)
  v_mfma_f32_32x32x16_bf16 v[128:143], v[224:227], v[0:3], 0
  v_mfma_f32_32x32x16_bf16 v[144:159], v[228:231], v[0:3], 0
  ds_read_b64_tr_b16 v[224:225], v176 offset:8192
  ds_read_b64_tr_b16 v[226:227], v176 offset:8448
  ds_read_b64_tr_b16 v[228:229], v176 offset:12288
  ds_read_b64_tr_b16 v[230:231], v176 offset:12544
  s_waitcnt lgkmcnt(12)
  v_mfma_f32_32x32x16_bf16 v[128:143], v[232:235], v[4:7], v[128:143]
  v_mfma_f32_32x32x16_bf16 v[144:159], v[236:239], v[4:7], v[144:159]
  ds_read_b64_tr_b16 v[232:233], v176 offset:8704
  ds_read_b64_tr_b16 v[234:235], v176 offset:8960
  ds_read_b64_tr_b16 v[236:237], v176 offset:12800
  ds_read_b64_tr_b16 v[238:239], v176 offset:13056
  s_waitcnt lgkmcnt(12)
  v_mfma_f32_32x32x16_bf16 v[128:143], v[240:243], v[8:11], v[128:143]
  v_mfma_f32_32x32x16_bf16 v[144:159], v[244:247], v[8:11], v[144:159]
  ds_read_b64_tr_b16 v[240:241], v176 offset:9216
  ds_read_b64_tr_b16 v[242:243], v176 offset:9472
  ds_read_b64_tr_b16 v[244:245], v176 offset:13312
  ds_read_b64_tr_b16 v[246:247], v176 offset:13568
  s_waitcnt lgkmcnt(12)
  v_mfma_f32_32x32x16_bf16 v[128:143], v[248:251], v[12:15], v[128:143]
  v_mfma_f32_32x32x16_bf16 v[144:159], v[252:255], v[12:15], v[144:159]
  s_waitcnt vmcnt(24)
  s_barrier
  s_add_u32 s55, s62, 57344
  s_mov_b32 m0, s55
  s_nop 0
  buffer_load_dwordx4 v177, s[28:31], s36 offen lds
  s_add_u32 s55, s62, 61440
  s_mov_b32 m0, s55
  s_nop 0
  buffer_load_dwordx4 v177, s[32:35], s37 offen lds
  s_add_u32 s36, s36, s38
  s_add_u32 s37, s37, s38
  ds_read_b64_tr_b16 v[248:249], v176 offset:9728
  ds_read_b64_tr_b16 v[250:251], v176 offset:9984
  ds_read_b64_tr_b16 v[252:253], v176 offset:13824
  ds_read_b64_tr_b16 v[254:255], v176 offset:14080
  s_waitcnt lgkmcnt(12)
  v_mfma_f32_32x32x16_bf16 v[128:143], v[224:227], v[16:19], v[128:143]
  v_mfma_f32_32x32x16_bf16 v[144:159], v[228:231], v[16:19], v[144:159]
  ds_read_b64_tr_b16 v[224:225], v176 offset:16384
  ds_read_b64_tr_b16 v[226:227], v176 offset:16640
  ds_read_b64_tr_b16 v[228:229], v176 offset:20480
  ds_read_b64_tr_b16 v[230:231], v176 offset:20736
  s_waitcnt lgkmcnt(12)
  v_mfma_f32_32x32x16_bf16 v[128:143], v[232:235], v[20:23], v[128:143]
  v_mfma_f32_32x32x16_bf16 v[144:159], v[236:239], v[20:23], v[144:159]
  ds_read_b64_tr_b16 v[232:233], v176 offset:16896
  ds_read_b64_tr_b16 v[234:235], v176 offset:17152
  ds_read_b64_tr_b16 v[236:237], v176 offset:20992
  ds_read_b64_tr_b16 v[238:239], v176 offset:21248
  s_waitcnt lgkmcnt(12)
  v_mfma_f32_32x32x16_bf16 v[128:143], v[240:243], v[24:27], v[128:143]
  v_mfma_f32_32x32x16_bf16 v[144:159], v[244:247], v[24:27], v[144:159]
  ds_read_b64_tr_b16 v[240:241], v176 offset:17408
  ds_read_b64_tr_b16 v[242:243], v176 offset:17664
  ds_read_b64_tr_b16 v[244:245], v176 offset:21504
  ds_read_b64_tr_b16 v[246:247], v176 offset:21760
  s_waitcnt lgkmcnt(12)
  v_mfma_f32_32x32x16_bf16 v[128:143], v[248:251], v[28:31], v[128:143]
  v_mfma_f32_32x32x16_bf16 v[144:159], v[252:255], v[28:31], v[144:159]
  s_waitcnt vmcnt(24)
  s_barrier
  s_add_u32 s57, s57, 1
  s_min_u32 s54, s57, 79
  s_cmp_lt_u32 s54, 24
  s_cbranch_scc0 L_k1_gu2
  s_mov_b32 s28, s12
  s_mov_b32 s32, s12
  s_mov_b32 s29, s13
  s_mov_b32 s33, s13
  s_mov_b32 s30, s14
  s_mov_b32 s34, s14
  s_mov_b32 s31, s15
  s_mov_b32 s35, s15
  s_lshl_b32 s36, s54, 7
  s_add_u32 s37, s36, 64
  s_mov_b32 s38, 196608
  v_mov_b32 v177, v178
  s_branch L_k1_sd2
L_k1_gu2:
  s_nop 7
  s_nop 4
  s_mov_b32 s28, s16
  s_mov_b32 s32, s20
  s_mov_b32 s29, s17
  s_mov_b32 s33, s21
  s_mov_b32 s30, s18
  s_mov_b32 s34, s22
  s_mov_b32 s31, s19
  s_mov_b32 s35, s23
  s_sub_u32 s36, s54, 24
  s_lshl_b32 s36, s36, 6
  s_mov_b32 s37, s36
  s_mov_b32 s38, 229376
  v_mov_b32 v177, v179
L_k1_sd2:
  s_nop 7
  s_nop 4
  s_xor_b32 s62, s62, 0x10000
  s_add_u32 s55, s62, 0
  s_mov_b32 m0, s55
  s_nop 0
  buffer_load_dwordx4 v177, s[28:31], s36 offen lds
  s_add_u32 s55, s62, 4096
  s_mov_b32 m0, s55
  s_nop 0
  buffer_load_dwordx4 v177, s[32:35], s37 offen lds
  s_add_u32 s36, s36, s38
  s_add_u32 s37, s37, s38
  ds_read_b64_tr_b16 v[248:249], v176 offset:17920
  ds_read_b64_tr_b16 v[250:251], v176 offset:18176
  ds_read_b64_tr_b16 v[252:253], v176 offset:22016
  ds_read_b64_tr_b16 v[254:255], v176 offset:22272
  s_waitcnt lgkmcnt(12)
  v_mfma_f32_32x32x16_bf16 v[128:143], v[224:227], v[32:35], v[128:143]
  v_mfma_f32_32x32x16_bf16 v[144:159], v[228:231], v[32:35], v[144:159]
  ds_read_b64_tr_b16 v[224:225], v176 offset:24576
  ds_read_b64_tr_b16 v[226:227], v176 offset:24832
  ds_read_b64_tr_b16 v[228:229], v176 offset:28672
  ds_read_b64_tr_b16 v[230:231], v176 offset:28928
  s_waitcnt lgkmcnt(12)
  v_mfma_f32_32x32x16_bf16 v[128:143], v[232:235], v[36:39], v[128:143]
  v_mfma_f32_32x32x16_bf16 v[144:159], v[236:239], v[36:39], v[144:159]
  ds_read_b64_tr_b16 v[232:233], v176 offset:25088
  ds_read_b64_tr_b16 v[234:235], v176 offset:25344
  ds_read_b64_tr_b16 v[236:237], v176 offset:29184
  ds_read_b64_tr_b16 v[238:239], v176 offset:29440
  s_waitcnt lgkmcnt(12)
  v_mfma_f32_32x32x16_bf16 v[128:143], v[240:243], v[40:43], v[128:143]
  v_mfma_f32_32x32x16_bf16 v[144:159], v[244:247], v[40:43], v[144:159]
  ds_read_b64_tr_b16 v[240:241], v176 offset:25600
  ds_read_b64_tr_b16 v[242:243], v176 offset:25856
  ds_read_b64_tr_b16 v[244:245], v176 offset:29696
  ds_read_b64_tr_b16 v[246:247], v176 offset:29952
  s_waitcnt lgkmcnt(12)
  v_mfma_f32_32x32x16_bf16 v[128:143], v[248:251], v[44:47], v[128:143]
  v_mfma_f32_32x32x16_bf16 v[144:159], v[252:255], v[44:47], v[144:159]
  s_waitcnt vmcnt(24)
  s_barrier
  s_add_u32 s55, s62, 8192
  s_mov_b32 m0, s55
  s_nop 0
  buffer_load_dwordx4 v177, s[28:31], s36 offen lds
  s_add_u32 s55, s62, 12288
  s_mov_b32 m0, s55
  s_nop 0
  buffer_load_dwordx4 v177, s[32:35], s37 offen lds
  s_add_u32 s36, s36, s38
  s_add_u32 s37, s37, s38
  ds_read_b64_tr_b16 v[248:249], v176 offset:26112
  ds_read_b64_tr_b16 v[250:251], v176 offset:26368
  ds_read_b64_tr_b16 v[252:253], v176 offset:30208
  ds_read_b64_tr_b16 v[254:255], v176 offset:30464
  s_waitcnt lgkmcnt(12)
  v_mfma_f32_32x32x16_bf16 v[128:143], v[224:227], v[48:51], v[128:143]
  v_mfma_f32_32x32x16_bf16 v[144:159], v[228:231], v[48:51], v[144:159]
  ds_read_b64_tr_b16 v[224:225], v176 offset:32768
  ds_read_b64_tr_b16 v[226:227], v176 offset:33024
  ds_read_b64_tr_b16 v[228:229], v176 offset:36864
  ds_read_b64_tr_b16 v[230:231], v176 offset:37120
  s_waitcnt lgkmcnt(12)
  v_mfma_f32_32x32x16_bf16 v[128:143], v[232:235], v[52:55], v[128:143]
  v_mfma_f32_32x32x16_bf16 v[144:159], v[236:239], v[52:55], v[144:159]
  ds_read_b64_tr_b16 v[232:233], v176 offset:33280
  ds_read_b64_tr_b16 v[234:235], v176 offset:33536
  ds_read_b64_tr_b16 v[236:237], v176 offset:37376
  ds_read_b64_tr_b16 v[238:239], v176 offset:37632
  s_waitcnt lgkmcnt(12)
  v_mfma_f32_32x32x16_bf16 v[128:143], v[240:243], v[56:59], v[128:143]
  v_mfma_f32_32x32x16_bf16 v[144:159], v[244:247], v[56:59], v[144:159]
  ds_read_b64_tr_b16 v[240:241], v176 offset:33792
  ds_read_b64_tr_b16 v[242:243], v176 offset:34048
  ds_read_b64_tr_b16 v[244:245], v176 offset:37888
  ds_read_b64_tr_b16 v[246:247], v176 offset:38144
  s_waitcnt lgkmcnt(12)
  v_mfma_f32_32x32x16_bf16 v[128:143], v[248:251], v[60:63], v[128:143]
  v_mfma_f32_32x32x16_bf16 v[144:159], v[252:255], v[60:63], v[144:159]
  s_waitcnt vmcnt(24)
  s_barrier
  s_add_u32 s55, s62, 16384
  s_mov_b32 m0, s55
  s_nop 0
  buffer_load_dwordx4 v177, s[28:31], s36 offen lds
  s_add_u32 s55, s62, 20480
  s_mov_b32 m0, s55
  s_nop 0
  buffer_load_dwordx4 v177, s[32:35], s37 offen lds
  s_add_u32 s36, s36, s38
  s_add_u32 s37, s37, s38
  ds_read_b64_tr_b16 v[248:249], v176 offset:34304
  ds_read_b64_tr_b16 v[250:251], v176 offset:34560
  ds_read_b64_tr_b16 v[252:253], v176 offset:38400
  ds_read_b64_tr_b16 v[254:255], v176 offset:38656
  s_waitcnt lgkmcnt(12)
  v_mfma_f32_32x32x16_bf16 v[128:143], v[224:227], v[64:67], v[128:143]
  v_mfma_f32_32x32x16_bf16 v[144:159], v[228:231], v[64:67], v[144:159]
  ds_read_b64_tr_b16 v[224:225], v176 offset:40960
  ds_read_b64_tr_b16 v[226:227], v176 offset:41216
  ds_read_b64_tr_b16 v[228:229], v176 offset:45056
  ds_read_b64_tr_b16 v[230:231], v176 offset:45312
  s_waitcnt lgkmcnt(12)
  v_mfma_f32_32x32x16_bf16 v[128:143], v[232:235], v[68:71], v[128:143]
  v_mfma_f32_32x32x16_bf16 v[144:159], v[236:239], v[68:71], v[144:159]
  ds_read_b64_tr_b16 v[232:233], v176 offset:41472
  ds_read_b64_tr_b16 v[234:235], v176 offset:41728
  ds_read_b64_tr_b16 v[236:237], v176 offset:45568
  ds_read_b64_tr_b16 v[238:239], v176 offset:45824
  s_waitcnt lgkmcnt(12)
  v_mfma_f32_32x32x16_bf16 v[128:143], v[240:243], v[72:75], v[128:143]
  v_mfma_f32_32x32x16_bf16 v[144:159], v[244:247], v[72:75], v[144:159]
  ds_read_b64_tr_b16 v[240:241], v176 offset:41984
  ds_read_b64_tr_b16 v[242:243], v176 offset:42240
  ds_read_b64_tr_b16 v[244:245], v176 offset:46080
  ds_read_b64_tr_b16 v[246:247], v176 offset:46336
  s_waitcnt lgkmcnt(12)
  v_mfma_f32_32x32x16_bf16 v[128:143], v[248:251], v[76:79], v[128:143]
  v_mfma_f32_32x32x16_bf16 v[144:159], v[252:255], v[76:79], v[144:159]
  s_waitcnt vmcnt(24)
  s_barrier
  s_add_u32 s55, s62, 24576
  s_mov_b32 m0, s55
  s_nop 0
  buffer_load_dwordx4 v177, s[28:31], s36 offen lds
  s_add_u32 s55, s62, 28672
  s_mov_b32 m0, s55
  s_nop 0
  buffer_load_dwordx4 v177, s[32:35], s37 offen lds
  s_add_u32 s36, s36, s38
  s_add_u32 s37, s37, s38
  ds_read_b64_tr_b16 v[248:249], v176 offset:42496
  ds_read_b64_tr_b16 v[250:251], v176 offset:42752
  ds_read_b64_tr_b16 v[252:253], v176 offset:46592
  ds_read_b64_tr_b16 v[254:255], v176 offset:46848
  s_waitcnt lgkmcnt(12)
  v_mfma_f32_32x32x16_bf16 v[128:143], v[224:227], v[80:83], v[128:143]
  v_mfma_f32_32x32x16_bf16 v[144:159], v[228:231], v[80:83], v[144:159]
  ds_read_b64_tr_b16 v[224:225], v176 offset:49152
  ds_read_b64_tr_b16 v[226:227], v176 offset:49408
  ds_read_b64_tr_b16 v[228:229], v176 offset:53248
  ds_read_b64_tr_b16 v[230:231], v176 offset:53504
  s_waitcnt lgkmcnt(12)
  v_mfma_f32_32x32x16_bf16 v[128:143], v[232:235], v[84:87], v[128:143]
  v_mfma_f32_32x32x16_bf16 v[144:159], v[236:239], v[84:87], v[144:159]
  ds_read_b64_tr_b16 v[232:233], v176 offset:49664
  ds_read_b64_tr_b16 v[234:235], v176 offset:49920
  ds_read_b64_tr_b16 v[236:237], v176 offset:53760
  ds_read_b64_tr_b16 v[238:239], v176 offset:54016
  s_waitcnt lgkmcnt(12)
  v_mfma_f32_32x32x16_bf16 v[128:143], v[240:243], v[88:91], v[128:143]
  v_mfma_f32_32x32x16_bf16 v[144:159], v[244:247], v[88:91], v[144:159]
  ds_read_b64_tr_b16 v[240:241], v176 offset:50176
  ds_read_b64_tr_b16 v[242:243], v176 offset:50432
  ds_read_b64_tr_b16 v[244:245], v176 offset:54272
  ds_read_b64_tr_b16 v[246:247], v176 offset:54528
  s_waitcnt lgkmcnt(12)
  v_mfma_f32_32x32x16_bf16 v[128:143], v[248:251], v[92:95], v[128:143]
  v_mfma_f32_32x32x16_bf16 v[144:159], v[252:255], v[92:95], v[144:159]
  s_waitcnt vmcnt(24)
  s_barrier
  s_add_u32 s55, s62, 32768
  s_mov_b32 m0, s55
  s_nop 0
  buffer_load_dwordx4 v177, s[28:31], s36 offen lds
  s_add_u32 s55, s62, 36864
  s_mov_b32 m0, s55
  s_nop 0
  buffer_load_dwordx4 v177, s[32:35], s37 offen lds
  s_add_u32 s36, s36, s38
  s_add_u32 s37, s37, s38
  ds_read_b64_tr_b16 v[248:249], v176 offset:50688
  ds_read_b64_tr_b16 v[250:251], v176 offset:50944
  ds_read_b64_tr_b16 v[252:253], v176 offset:54784
  ds_read_b64_tr_b16 v[254:255], v176 offset:55040
  s_waitcnt lgkmcnt(12)
  v_mfma_f32_32x32x16_bf16 v[128:143], v[224:227], v[96:99], v[128:143]
  v_mfma_f32_32x32x16_bf16 v[144:159], v[228:231], v[96:99], v[144:159]
  ds_read_b64_tr_b16 v[224:225], v176 offset:57344
  ds_read_b64_tr_b16 v[226:227], v176 offset:57600
  ds_read_b64_tr_b16 v[228:229], v176 offset:61440
  ds_read_b64_tr_b16 v[230:231], v176 offset:61696
  s_waitcnt lgkmcnt(12)
  v_mfma_f32_32x32x16_bf16 v[128:143], v[232:235], v[100:103], v[128:143]
  v_mfma_f32_32x32x16_bf16 v[144:159], v[236:239], v[100:103], v[144:159]
  ds_read_b64_tr_b16 v[232:233], v176 offset:57856
  ds_read_b64_tr_b16 v[234:235], v176 offset:58112
  ds_read_b64_tr_b16 v[236:237], v176 offset:61952
  ds_read_b64_tr_b16 v[238:239], v176 offset:62208
  s_waitcnt lgkmcnt(12)
  v_mfma_f32_32x32x16_bf16 v[128:143], v[240:243], v[104:107], v[128:143]
  v_mfma_f32_32x32x16_bf16 v[144:159], v[244:247], v[104:107], v[144:159]
  ds_read_b64_tr_b16 v[240:241], v176 offset:58368
  ds_read_b64_tr_b16 v[242:243], v176 offset:58624
  ds_read_b64_tr_b16 v[244:245], v176 offset:62464
  ds_read_b64_tr_b16 v[246:247], v176 offset:62720
  s_waitcnt lgkmcnt(12)
  v_mfma_f32_32x32x16_bf16 v[128:143], v[248:251], v[108:111], v[128:143]
  v_mfma_f32_32x32x16_bf16 v[144:159], v[252:255], v[108:111], v[144:159]
  s_waitcnt vmcnt(24)
  s_barrier
  s_add_u32 s55, s62, 40960
  s_mov_b32 m0, s55
  s_nop 0
  buffer_load_dwordx4 v177, s[28:31], s36 offen lds
  s_add_u32 s55, s62, 45056
  s_mov_b32 m0, s55
  s_nop 0
  buffer_load_dwordx4 v177, s[32:35], s37 offen lds
  s_add_u32 s36, s36, s38
  s_add_u32 s37, s37, s38
  ds_read_b64_tr_b16 v[248:249], v176 offset:58880
  ds_read_b64_tr_b16 v[250:251], v176 offset:59136
  ds_read_b64_tr_b16 v[252:253], v176 offset:62976
  ds_read_b64_tr_b16 v[254:255], v176 offset:63232
  s_waitcnt lgkmcnt(12)
  v_mfma_f32_32x32x16_bf16 v[128:143], v[224:227], v[112:115], v[128:143]
  v_mfma_f32_32x32x16_bf16 v[144:159], v[228:231], v[112:115], v[144:159]
  ds_read_b64_tr_b16 v[224:225], v187 offset:0
  ds_read_b64_tr_b16 v[226:227], v187 offset:256
  ds_read_b64_tr_b16 v[228:229], v187 offset:4096
  ds_read_b64_tr_b16 v[230:231], v187 offset:4352
  s_waitcnt lgkmcnt(12)
  v_mfma_f32_32x32x16_bf16 v[128:143], v[232:235], v[116:119], v[128:143]
  v_mfma_f32_32x32x16_bf16 v[144:159], v[236:239], v[116:119], v[144:159]
  ds_read_b64_tr_b16 v[232:233], v187 offset:512
  ds_read_b64_tr_b16 v[234:235], v187 offset:768
  ds_read_b64_tr_b16 v[236:237], v187 offset:4608
  ds_read_b64_tr_b16 v[238:239], v187 offset:4864
  s_waitcnt lgkmcnt(12)
  v_mfma_f32_32x32x16_bf16 v[128:143], v[240:243], v[120:123], v[128:143]
  v_mfma_f32_32x32x16_bf16 v[144:159], v[244:247], v[120:123], v[144:159]
  ds_read_b64_tr_b16 v[240:241], v187 offset:1024
  ds_read_b64_tr_b16 v[242:243], v187 offset:1280
  ds_read_b64_tr_b16 v[244:245], v187 offset:5120
  ds_read_b64_tr_b16 v[246:247], v187 offset:5376
  s_waitcnt lgkmcnt(12)
  v_mfma_f32_32x32x16_bf16 v[128:143], v[248:251], v[124:127], v[128:143]
  v_mfma_f32_32x32x16_bf16 v[144:159], v[252:255], v[124:127], v[144:159]
  s_cmp_ge_u32 s7, 24
  s_cbranch_scc1 L_k1_epGU
  s_lshr_b32 s58, s7, 3
  s_lshl_b32 s58, s58, 21
  s_and_b32 s59, s7, 7
  s_lshl_b32 s59, s59, 18
  s_add_u32 s58, s58, s59
  s_nop 3
  v_cvt_pk_bf16_f32 v190, v128, v129
  v_cvt_pk_bf16_f32 v191, v130, v131
  v_cvt_pk_bf16_f32 v192, v132, v133
  v_cvt_pk_bf16_f32 v193, v134, v135
  v_cvt_pk_bf16_f32 v194, v136, v137
  v_cvt_pk_bf16_f32 v195, v138, v139
  v_cvt_pk_bf16_f32 v196, v140, v141
  v_cvt_pk_bf16_f32 v197, v142, v143
  v_permlane32_swap_b32 v190, v192
  v_permlane32_swap_b32 v191, v193
  v_permlane32_swap_b32 v194, v196
  v_permlane32_swap_b32 v195, v197
  s_add_u32 s59, s58, 0
  buffer_store_dwordx4 v[190:193], v183, s[24:27], s59 offen
  s_add_u32 s59, s58, 65536
  buffer_store_dwordx4 v[194:197], v183, s[24:27], s59 offen
  v_cvt_pk_bf16_f32 v190, v144, v145
  v_cvt_pk_bf16_f32 v191, v146, v147
  v_cvt_pk_bf16_f32 v192, v148, v149
  v_cvt_pk_bf16_f32 v193, v150, v151
  v_cvt_pk_bf16_f32 v194, v152, v153
  v_cvt_pk_bf16_f32 v195, v154, v155
  v_cvt_pk_bf16_f32 v196, v156, v157
  v_cvt_pk_bf16_f32 v197, v158, v159
  v_permlane32_swap_b32 v190, v192
  v_permlane32_swap_b32 v191, v193
  v_permlane32_swap_b32 v194, v196
  v_permlane32_swap_b32 v195, v197
  s_add_u32 s59, s58, 131072
  buffer_store_dwordx4 v[190:193], v183, s[24:27], s59 offen
  s_add_u32 s59, s58, 196608
  buffer_store_dwordx4 v[194:197], v183, s[24:27], s59 offen
  s_branch L_k1_next
L_k1_epGU:
  s_nop 7
  s_nop 4
  s_mov_b32 s60, 0x3d372713
  s_mov_b32 s61, 0xc0135761
  v_mul_f32 v200, v128, v128
  v_fma_f32 v200, v200, s60, 1.0
  v_mul_f32 v200, v200, v128
  v_mul_f32 v200, s61, v200
  v_exp_f32 v200, v200
  s_nop 0
  v_add_f32 v200, 1.0, v200
  v_rcp_f32 v200, v200
  v_mul_f32 v201, v128, v144
  v_mul_f32 v128, v200, v201
  v_mul_f32 v203, v129, v129
  v_fma_f32 v203, v203, s60, 1.0
  v_mul_f32 v203, v203, v129
  v_mul_f32 v203, s61, v203
  v_exp_f32 v203, v203
  s_nop 0
  v_add_f32 v203, 1.0, v203
  v_rcp_f32 v203, v203
  v_mul_f32 v204, v129, v145
  v_mul_f32 v129, v203, v204
  v_mul_f32 v206, v130, v130
  v_fma_f32 v206, v206, s60, 1.0
  v_mul_f32 v206, v206, v130
  v_mul_f32 v206, s61, v206
  v_exp_f32 v206, v206
  s_nop 0
  v_add_f32 v206, 1.0, v206
  v_rcp_f32 v206, v206
  v_mul_f32 v207, v130, v146
  v_mul_f32 v130, v206, v207
  v_mul_f32 v209, v131, v131
  v_fma_f32 v209, v209, s60, 1.0
  v_mul_f32 v209, v209, v131
  v_mul_f32 v209, s61, v209
  v_exp_f32 v209, v209
  s_nop 0
  v_add_f32 v209, 1.0, v209
  v_rcp_f32 v209, v209
  v_mul_f32 v210, v131, v147
  v_mul_f32 v131, v209, v210
  v_mul_f32 v200, v132, v132
  v_fma_f32 v200, v200, s60, 1.0
  v_mul_f32 v200, v200, v132
  v_mul_f32 v200, s61, v200
  v_exp_f32 v200, v200
  s_nop 0
  v_add_f32 v200, 1.0, v200
  v_rcp_f32 v200, v200
  v_mul_f32 v201, v132, v148
  v_mul_f32 v132, v200, v201
  v_mul_f32 v203, v133, v133
  v_fma_f32 v203, v203, s60, 1.0
  v_mul_f32 v203, v203, v133
  v_mul_f32 v203, s61, v203
  v_exp_f32 v203, v203
  s_nop 0
  v_add_f32 v203, 1.0, v203
  v_rcp_f32 v203, v203
  v_mul_f32 v204, v133, v149
  v_mul_f32 v133, v203, v204
  v_mul_f32 v206, v134, v134
  v_fma_f32 v206, v206, s60, 1.0
  v_mul_f32 v206, v206, v134
  v_mul_f32 v206, s61, v206
  v_exp_f32 v206, v206
  s_nop 0
  v_add_f32 v206, 1.0, v206
  v_rcp_f32 v206, v206
  v_mul_f32 v207, v134, v150
  v_mul_f32 v134, v206, v207
  v_mul_f32 v209, v135, v135
  v_fma_f32 v209, v209, s60, 1.0
  v_mul_f32 v209, v209, v135
  v_mul_f32 v209, s61, v209
  v_exp_f32 v209, v209
  s_nop 0
  v_add_f32 v209, 1.0, v209
  v_rcp_f32 v209, v209
  v_mul_f32 v210, v135, v151
  v_mul_f32 v135, v209, v210
  v_mul_f32 v200, v136, v136
  v_fma_f32 v200, v200, s60, 1.0
  v_mul_f32 v200, v200, v136
  v_mul_f32 v200, s61, v200
  v_exp_f32 v200, v200
  s_nop 0
  v_add_f32 v200, 1.0, v200
  v_rcp_f32 v200, v200
  v_mul_f32 v201, v136, v152
  v_mul_f32 v136, v200, v201
  v_mul_f32 v203, v137, v137
  v_fma_f32 v203, v203, s60, 1.0
  v_mul_f32 v203, v203, v137
  v_mul_f32 v203, s61, v203
  v_exp_f32 v203, v203
  s_nop 0
  v_add_f32 v203, 1.0, v203
  v_rcp_f32 v203, v203
  v_mul_f32 v204, v137, v153
  v_mul_f32 v137, v203, v204
  v_mul_f32 v206, v138, v138
  v_fma_f32 v206, v206, s60, 1.0
  v_mul_f32 v206, v206, v138
  v_mul_f32 v206, s61, v206
  v_exp_f32 v206, v206
  s_nop 0
  v_add_f32 v206, 1.0, v206
  v_rcp_f32 v206, v206
  v_mul_f32 v207, v138, v154
  v_mul_f32 v138, v206, v207
  v_mul_f32 v209, v139, v139
  v_fma_f32 v209, v209, s60, 1.0
  v_mul_f32 v209, v209, v139
  v_mul_f32 v209, s61, v209
  v_exp_f32 v209, v209
  s_nop 0
  v_add_f32 v209, 1.0, v209
  v_rcp_f32 v209, v209
  v_mul_f32 v210, v139, v155
  v_mul_f32 v139, v209, v210
  v_mul_f32 v200, v140, v140
  v_fma_f32 v200, v200, s60, 1.0
  v_mul_f32 v200, v200, v140
  v_mul_f32 v200, s61, v200
  v_exp_f32 v200, v200
  s_nop 0
  v_add_f32 v200, 1.0, v200
  v_rcp_f32 v200, v200
  v_mul_f32 v201, v140, v156
  v_mul_f32 v140, v200, v201
  v_mul_f32 v203, v141, v141
  v_fma_f32 v203, v203, s60, 1.0
  v_mul_f32 v203, v203, v141
  v_mul_f32 v203, s61, v203
  v_exp_f32 v203, v203
  s_nop 0
  v_add_f32 v203, 1.0, v203
  v_rcp_f32 v203, v203
  v_mul_f32 v204, v141, v157
  v_mul_f32 v141, v203, v204
  v_mul_f32 v206, v142, v142
  v_fma_f32 v206, v206, s60, 1.0
  v_mul_f32 v206, v206, v142
  v_mul_f32 v206, s61, v206
  v_exp_f32 v206, v206
  s_nop 0
  v_add_f32 v206, 1.0, v206
  v_rcp_f32 v206, v206
  v_mul_f32 v207, v142, v158
  v_mul_f32 v142, v206, v207
  v_mul_f32 v209, v143, v143
  v_fma_f32 v209, v209, s60, 1.0
  v_mul_f32 v209, v209, v143
  v_mul_f32 v209, s61, v209
  v_exp_f32 v209, v209
  s_nop 0
  v_add_f32 v209, 1.0, v209
  v_rcp_f32 v209, v209
  v_mul_f32 v210, v143, v159
  v_mul_f32 v143, v209, v210
  v_cvt_pk_bf16_f32 v190, v128, v129
  v_cvt_pk_bf16_f32 v191, v130, v131
  v_cvt_pk_bf16_f32 v192, v132, v133
  v_cvt_pk_bf16_f32 v193, v134, v135
  v_cvt_pk_bf16_f32 v194, v136, v137
  v_cvt_pk_bf16_f32 v195, v138, v139
  v_cvt_pk_bf16_f32 v196, v140, v141
  v_cvt_pk_bf16_f32 v197, v142, v143
  v_permlane32_swap_b32 v190, v192
  v_permlane32_swap_b32 v191, v193
  v_permlane32_swap_b32 v194, v196
  v_permlane32_swap_b32 v195, v197
  s_sub_u32 s58, s7, 24
  s_lshl_b32 s58, s58, 6
  s_add_u32 s58, s58, 6291456
  buffer_store_dwordx4 v[190:193], v184, s[24:27], s58 offen
  buffer_store_dwordx4 v[194:197], v184, s[24:27], s58 offen offset:32
  s_branch L_k1_next
L_k1_bodyB:
  s_nop 7
  s_nop 4
  s_waitcnt vmcnt(24)
  s_barrier
  s_add_u32 s55, s62, 49152
  s_mov_b32 m0, s55
  s_nop 0
  buffer_load_dwordx4 v177, s[28:31], s36 offen lds
  s_add_u32 s55, s62, 53248
  s_mov_b32 m0, s55
  s_nop 0
  buffer_load_dwordx4 v177, s[32:35], s37 offen lds
  s_add_u32 s36, s36, s38
  s_add_u32 s37, s37, s38
  ds_read_b64_tr_b16 v[248:249], v176 offset:1536
  ds_read_b64_tr_b16 v[250:251], v176 offset:1792
  ds_read_b64_tr_b16 v[252:253], v176 offset:5632
  ds_read_b64_tr_b16 v[254:255], v176 offset:5888
  s_waitcnt lgkmcnt(12)
  v_mfma_f32_32x32x16_bf16 v[128:143], v[0:3], v[224:227], 0
  v_mfma_f32_32x32x16_bf16 v[144:159], v[0:3], v[228:231], 0
  ds_read_b64_tr_b16 v[224:225], v176 offset:8192
  ds_read_b64_tr_b16 v[226:227], v176 offset:8448
  ds_read_b64_tr_b16 v[228:229], v176 offset:12288
  ds_read_b64_tr_b16 v[230:231], v176 offset:12544
  s_waitcnt lgkmcnt(12)
  v_mfma_f32_32x32x16_bf16 v[128:143], v[4:7], v[232:235], v[128:143]
  v_mfma_f32_32x32x16_bf16 v[144:159], v[4:7], v[236:239], v[144:159]
  ds_read_b64_tr_b16 v[232:233], v176 offset:8704
  ds_read_b64_tr_b16 v[234:235], v176 offset:8960
  ds_read_b64_tr_b16 v[236:237], v176 offset:12800
  ds_read_b64_tr_b16 v[238:239], v176 offset:13056
  s_waitcnt lgkmcnt(12)
  v_mfma_f32_32x32x16_bf16 v[128:143], v[8:11], v[240:243], v[128:143]
  v_mfma_f32_32x32x16_bf16 v[144:159], v[8:11], v[244:247], v[144:159]
  ds_read_b64_tr_b16 v[240:241], v176 offset:9216
  ds_read_b64_tr_b16 v[242:243], v176 offset:9472
  ds_read_b64_tr_b16 v[244:245], v176 offset:13312
  ds_read_b64_tr_b16 v[246:247], v176 offset:13568
  s_waitcnt lgkmcnt(12)
  v_mfma_f32_32x32x16_bf16 v[128:143], v[12:15], v[248:251], v[128:143]
  v_mfma_f32_32x32x16_bf16 v[144:159], v[12:15], v[252:255], v[144:159]
  s_waitcnt vmcnt(24)
  s_barrier
  s_add_u32 s55, s62, 57344
  s_mov_b32 m0, s55
  s_nop 0
  buffer_load_dwordx4 v177, s[28:31], s36 offen lds
  s_add_u32 s55, s62, 61440
  s_mov_b32 m0, s55
  s_nop 0
  buffer_load_dwordx4 v177, s[32:35], s37 offen lds
  s_add_u32 s36, s36, s38
  s_add_u32 s37, s37, s38
  ds_read_b64_tr_b16 v[248:249], v176 offset:9728
  ds_read_b64_tr_b16 v[250:251], v176 offset:9984
  ds_read_b64_tr_b16 v[252:253], v176 offset:13824
  ds_read_b64_tr_b16 v[254:255], v176 offset:14080
  s_waitcnt lgkmcnt(12)
  v_mfma_f32_32x32x16_bf16 v[128:143], v[16:19], v[224:227], v[128:143]
  v_mfma_f32_32x32x16_bf16 v[144:159], v[16:19], v[228:231], v[144:159]
  ds_read_b64_tr_b16 v[224:225], v176 offset:16384
  ds_read_b64_tr_b16 v[226:227], v176 offset:16640
  ds_read_b64_tr_b16 v[228:229], v176 offset:20480
  ds_read_b64_tr_b16 v[230:231], v176 offset:20736
  s_waitcnt lgkmcnt(12)
  v_mfma_f32_32x32x16_bf16 v[128:143], v[20:23], v[232:235], v[128:143]
  v_mfma_f32_32x32x16_bf16 v[144:159], v[20:23], v[236:239], v[144:159]
  ds_read_b64_tr_b16 v[232:233], v176 offset:16896
  ds_read_b64_tr_b16 v[234:235], v176 offset:17152
  ds_read_b64_tr_b16 v[236:237], v176 offset:20992
  ds_read_b64_tr_b16 v[238:239], v176 offset:21248
  s_waitcnt lgkmcnt(12)
  v_mfma_f32_32x32x16_bf16 v[128:143], v[24:27], v[240:243], v[128:143]
  v_mfma_f32_32x32x16_bf16 v[144:159], v[24:27], v[244:247], v[144:159]
  ds_read_b64_tr_b16 v[240:241], v176 offset:17408
  ds_read_b64_tr_b16 v[242:243], v176 offset:17664
  ds_read_b64_tr_b16 v[244:245], v176 offset:21504
  ds_read_b64_tr_b16 v[246:247], v176 offset:21760
  s_waitcnt lgkmcnt(12)
  v_mfma_f32_32x32x16_bf16 v[128:143], v[28:31], v[248:251], v[128:143]
  v_mfma_f32_32x32x16_bf16 v[144:159], v[28:31], v[252:255], v[144:159]
  s_waitcnt vmcnt(24)
  s_barrier
  s_add_u32 s57, s57, 1
  s_min_u32 s54, s57, 79
  s_cmp_lt_u32 s54, 24
  s_cbranch_scc0 L_k1_gu3
  s_mov_b32 s28, s12
  s_mov_b32 s32, s12
  s_mov_b32 s29, s13
  s_mov_b32 s33, s13
  s_mov_b32 s30, s14
  s_mov_b32 s34, s14
  s_mov_b32 s31, s15
  s_mov_b32 s35, s15
  s_lshl_b32 s36, s54, 7
  s_add_u32 s37, s36, 64
  s_mov_b32 s38, 196608
  v_mov_b32 v177, v178
  s_branch L_k1_sd3
L_k1_gu3:
  s_nop 7
  s_nop 4
  s_mov_b32 s28, s16
  s_mov_b32 s32, s20
  s_mov_b32 s29, s17
  s_mov_b32 s33, s21
  s_mov_b32 s30, s18
  s_mov_b32 s34, s22
  s_mov_b32 s31, s19
  s_mov_b32 s35, s23
  s_sub_u32 s36, s54, 24
  s_lshl_b32 s36, s36, 6
  s_mov_b32 s37, s36
  s_mov_b32 s38, 229376
  v_mov_b32 v177, v179
L_k1_sd3:
  s_nop 7
  s_nop 4
  s_xor_b32 s62, s62, 0x10000
  s_add_u32 s55, s62, 0
  s_mov_b32 m0, s55
  s_nop 0
  buffer_load_dwordx4 v177, s[28:31], s36 offen lds
  s_add_u32 s55, s62, 4096
  s_mov_b32 m0, s55
  s_nop 0
  buffer_load_dwordx4 v177, s[32:35], s37 offen lds
  s_add_u32 s36, s36, s38
  s_add_u32 s37, s37, s38
  ds_read_b64_tr_b16 v[248:249], v176 offset:17920
  ds_read_b64_tr_b16 v[250:251], v176 offset:18176
  ds_read_b64_tr_b16 v[252:253], v176 offset:22016
  ds_read_b64_tr_b16 v[254:255], v176 offset:22272
  s_waitcnt lgkmcnt(12)
  v_mfma_f32_32x32x16_bf16 v[128:143], v[32:35], v[224:227], v[128:143]
  v_mfma_f32_32x32x16_bf16 v[144:159], v[32:35], v[228:231], v[144:159]
  ds_read_b64_tr_b16 v[224:225], v176 offset:24576
  ds_read_b64_tr_b16 v[226:227], v176 offset:24832
  ds_read_b64_tr_b16 v[228:229], v176 offset:28672
  ds_read_b64_tr_b16 v[230:231], v176 offset:28928
  s_waitcnt lgkmcnt(12)
  v_mfma_f32_32x32x16_bf16 v[128:143], v[36:39], v[232:235], v[128:143]
  v_mfma_f32_32x32x16_bf16 v[144:159], v[36:39], v[236:239], v[144:159]
  ds_read_b64_tr_b16 v[232:233], v176 offset:25088
  ds_read_b64_tr_b16 v[234:235], v176 offset:25344
  ds_read_b64_tr_b16 v[236:237], v176 offset:29184
  ds_read_b64_tr_b16 v[238:239], v176 offset:29440
  s_waitcnt lgkmcnt(12)
  v_mfma_f32_32x32x16_bf16 v[128:143], v[40:43], v[240:243], v[128:143]
  v_mfma_f32_32x32x16_bf16 v[144:159], v[40:43], v[244:247], v[144:159]
  ds_read_b64_tr_b16 v[240:241], v176 offset:25600
  ds_read_b64_tr_b16 v[242:243], v176 offset:25856
  ds_read_b64_tr_b16 v[244:245], v176 offset:29696
  ds_read_b64_tr_b16 v[246:247], v176 offset:29952
  s_waitcnt lgkmcnt(12)
  v_mfma_f32_32x32x16_bf16 v[128:143], v[44:47], v[248:251], v[128:143]
  v_mfma_f32_32x32x16_bf16 v[144:159], v[44:47], v[252:255], v[144:159]
  s_waitcnt vmcnt(24)
  s_barrier
  s_add_u32 s55, s62, 8192
  s_mov_b32 m0, s55
  s_nop 0
  buffer_load_dwordx4 v177, s[28:31], s36 offen lds
  s_add_u32 s55, s62, 12288
  s_mov_b32 m0, s55
  s_nop 0
  buffer_load_dwordx4 v177, s[32:35], s37 offen lds
  s_add_u32 s36, s36, s38
  s_add_u32 s37, s37, s38
  ds_read_b64_tr_b16 v[248:249], v176 offset:26112
  ds_read_b64_tr_b16 v[250:251], v176 offset:26368
  ds_read_b64_tr_b16 v[252:253], v176 offset:30208
  ds_read_b64_tr_b16 v[254:255], v176 offset:30464
  s_waitcnt lgkmcnt(12)
  v_mfma_f32_32x32x16_bf16 v[128:143], v[48:51], v[224:227], v[128:143]
  v_mfma_f32_32x32x16_bf16 v[144:159], v[48:51], v[228:231], v[144:159]
  ds_read_b64_tr_b16 v[224:225], v176 offset:32768
  ds_read_b64_tr_b16 v[226:227], v176 offset:33024
  ds_read_b64_tr_b16 v[228:229], v176 offset:36864
  ds_read_b64_tr_b16 v[230:231], v176 offset:37120
  s_waitcnt lgkmcnt(12)
  v_mfma_f32_32x32x16_bf16 v[128:143], v[52:55], v[232:235], v[128:143]
  v_mfma_f32_32x32x16_bf16 v[144:159], v[52:55], v[236:239], v[144:159]
  ds_read_b64_tr_b16 v[232:233], v176 offset:33280
  ds_read_b64_tr_b16 v[234:235], v176 offset:33536
  ds_read_b64_tr_b16 v[236:237], v176 offset:37376
  ds_read_b64_tr_b16 v[238:239], v176 offset:37632
  s_waitcnt lgkmcnt(12)
  v_mfma_f32_32x32x16_bf16 v[128:143], v[56:59], v[240:243], v[128:143]
  v_mfma_f32_32x32x16_bf16 v[144:159], v[56:59], v[244:247], v[144:159]
  ds_read_b64_tr_b16 v[240:241], v176 offset:33792
  ds_read_b64_tr_b16 v[242:243], v176 offset:34048
  ds_read_b64_tr_b16 v[244:245], v176 offset:37888
  ds_read_b64_tr_b16 v[246:247], v176 offset:38144
  s_waitcnt lgkmcnt(12)
  v_mfma_f32_32x32x16_bf16 v[128:143], v[60:63], v[248:251], v[128:143]
  v_mfma_f32_32x32x16_bf16 v[144:159], v[60:63], v[252:255], v[144:159]
  s_waitcnt vmcnt(24)
  s_barrier
  s_add_u32 s55, s62, 16384
  s_mov_b32 m0, s55
  s_nop 0
  buffer_load_dwordx4 v177, s[28:31], s36 offen lds
  s_add_u32 s55, s62, 20480
  s_mov_b32 m0, s55
  s_nop 0
  buffer_load_dwordx4 v177, s[32:35], s37 offen lds
  s_add_u32 s36, s36, s38
  s_add_u32 s37, s37, s38
  ds_read_b64_tr_b16 v[248:249], v176 offset:34304
  ds_read_b64_tr_b16 v[250:251], v176 offset:34560
  ds_read_b64_tr_b16 v[252:253], v176 offset:38400
  ds_read_b64_tr_b16 v[254:255], v176 offset:38656
  s_waitcnt lgkmcnt(12)
  v_mfma_f32_32x32x16_bf16 v[128:143], v[64:67], v[224:227], v[128:143]
  v_mfma_f32_32x32x16_bf16 v[144:159], v[64:67], v[228:231], v[144:159]
  ds_read_b64_tr_b16 v[224:225], v176 offset:40960
  ds_read_b64_tr_b16 v[226:227], v176 offset:41216
  ds_read_b64_tr_b16 v[228:229], v176 offset:45056
  ds_read_b64_tr_b16 v[230:231], v176 offset:45312
  s_waitcnt lgkmcnt(12)
  v_mfma_f32_32x32x16_bf16 v[128:143], v[68:71], v[232:235], v[128:143]
  v_mfma_f32_32x32x16_bf16 v[144:159], v[68:71], v[236:239], v[144:159]
  ds_read_b64_tr_b16 v[232:233], v176 offset:41472
  ds_read_b64_tr_b16 v[234:235], v176 offset:41728
  ds_read_b64_tr_b16 v[236:237], v176 offset:45568
  ds_read_b64_tr_b16 v[238:239], v176 offset:45824
  s_waitcnt lgkmcnt(12)
  v_mfma_f32_32x32x16_bf16 v[128:143], v[72:75], v[240:243], v[128:143]
  v_mfma_f32_32x32x16_bf16 v[144:159], v[72:75], v[244:247], v[144:159]
  ds_read_b64_tr_b16 v[240:241], v176 offset:41984
  ds_read_b64_tr_b16 v[242:243], v176 offset:42240
  ds_read_b64_tr_b16 v[244:245], v176 offset:46080
  ds_read_b64_tr_b16 v[246:247], v176 offset:46336
  s_waitcnt lgkmcnt(12)
  v_mfma_f32_32x32x16_bf16 v[128:143], v[76:79], v[248:251], v[128:143]
  v_mfma_f32_32x32x16_bf16 v[144:159], v[76:79], v[252:255], v[144:159]
  s_waitcnt vmcnt(24)
  s_barrier
  s_add_u32 s55, s62, 24576
  s_mov_b32 m0, s55
  s_nop 0
  buffer_load_dwordx4 v177, s[28:31], s36 offen lds
  s_add_u32 s55, s62, 28672
  s_mov_b32 m0, s55
  s_nop 0
  buffer_load_dwordx4 v177, s[32:35], s37 offen lds
  s_add_u32 s36, s36, s38
  s_add_u32 s37, s37, s38
  ds_read_b64_tr_b16 v[248:249], v176 offset:42496
  ds_read_b64_tr_b16 v[250:251], v176 offset:42752
  ds_read_b64_tr_b16 v[252:253], v176 offset:46592
  ds_read_b64_tr_b16 v[254:255], v176 offset:46848
  s_waitcnt lgkmcnt(12)
  v_mfma_f32_32x32x16_bf16 v[128:143], v[80:83], v[224:227], v[128:143]
  v_mfma_f32_32x32x16_bf16 v[144:159], v[80:83], v[228:231], v[144:159]
  ds_read_b64_tr_b16 v[224:225], v176 offset:49152
  ds_read_b64_tr_b16 v[226:227], v176 offset:49408
  ds_read_b64_tr_b16 v[228:229], v176 offset:53248
  ds_read_b64_tr_b16 v[230:231], v176 offset:53504
  s_waitcnt lgkmcnt(12)
  v_mfma_f32_32x32x16_bf16 v[128:143], v[84:87], v[232:235], v[128:143]
  v_mfma_f32_32x32x16_bf16 v[144:159], v[84:87], v[236:239], v[144:159]
  ds_read_b64_tr_b16 v[232:233], v176 offset:49664
  ds_read_b64_tr_b16 v[234:235], v176 offset:49920
  ds_read_b64_tr_b16 v[236:237], v176 offset:53760
  ds_read_b64_tr_b16 v[238:239], v176 offset:54016
  s_waitcnt lgkmcnt(12)
  v_mfma_f32_32x32x16_bf16 v[128:143], v[88:91], v[240:243], v[128:143]
  v_mfma_f32_32x32x16_bf16 v[144:159], v[88:91], v[244:247], v[144:159]
  ds_read_b64_tr_b16 v[240:241], v176 offset:50176
  ds_read_b64_tr_b16 v[242:243], v176 offset:50432
  ds_read_b64_tr_b16 v[244:245], v176 offset:54272
  ds_read_b64_tr_b16 v[246:247], v176 offset:54528
  s_waitcnt lgkmcnt(12)
  v_mfma_f32_32x32x16_bf16 v[128:143], v[92:95], v[248:251], v[128:143]
  v_mfma_f32_32x32x16_bf16 v[144:159], v[92:95], v[252:255], v[144:159]
  s_waitcnt vmcnt(24)
  s_barrier
  s_add_u32 s55, s62, 32768
  s_mov_b32 m0, s55
  s_nop 0
  buffer_load_dwordx4 v177, s[28:31], s36 offen lds
  s_add_u32 s55, s62, 36864
  s_mov_b32 m0, s55
  s_nop 0
  buffer_load_dwordx4 v177, s[32:35], s37 offen lds
  s_add_u32 s36, s36, s38
  s_add_u32 s37, s37, s38
  ds_read_b64_tr_b16 v[248:249], v176 offset:50688
  ds_read_b64_tr_b16 v[250:251], v176 offset:50944
  ds_read_b64_tr_b16 v[252:253], v176 offset:54784
  ds_read_b64_tr_b16 v[254:255], v176 offset:55040
  s_waitcnt lgkmcnt(12)
  v_mfma_f32_32x32x16_bf16 v[128:143], v[96:99], v[224:227], v[128:143]
  v_mfma_f32_32x32x16_bf16 v[144:159], v[96:99], v[228:231], v[144:159]
  ds_read_b64_tr_b16 v[224:225], v176 offset:57344
  ds_read_b64_tr_b16 v[226:227], v176 offset:57600
  ds_read_b64_tr_b16 v[228:229], v176 offset:61440
  ds_read_b64_tr_b16 v[230:231], v176 offset:61696
  s_waitcnt lgkmcnt(12)
  v_mfma_f32_32x32x16_bf16 v[128:143], v[100:103], v[232:235], v[128:143]
  v_mfma_f32_32x32x16_bf16 v[144:159], v[100:103], v[236:239], v[144:159]
  ds_read_b64_tr_b16 v[232:233], v176 offset:57856
  ds_read_b64_tr_b16 v[234:235], v176 offset:58112
  ds_read_b64_tr_b16 v[236:237], v176 offset:61952
  ds_read_b64_tr_b16 v[238:239], v176 offset:62208
  s_waitcnt lgkmcnt(12)
  v_mfma_f32_32x32x16_bf16 v[128:143], v[104:107], v[240:243], v[128:143]
  v_mfma_f32_32x32x16_bf16 v[144:159], v[104:107], v[244:247], v[144:159]
  ds_read_b64_tr_b16 v[240:241], v176 offset:58368
  ds_read_b64_tr_b16 v[242:243], v176 offset:58624
  ds_read_b64_tr_b16 v[244:245], v176 offset:62464
  ds_read_b64_tr_b16 v[246:247], v176 offset:62720
  s_waitcnt lgkmcnt(12)
  v_mfma_f32_32x32x16_bf16 v[128:143], v[108:111], v[248:251], v[128:143]
  v_mfma_f32_32x32x16_bf16 v[144:159], v[108:111], v[252:255], v[144:159]
  s_waitcnt vmcnt(24)
  s_barrier
  s_add_u32 s55, s62, 40960
  s_mov_b32 m0, s55
  s_nop 0
  buffer_load_dwordx4 v177, s[28:31], s36 offen lds
  s_add_u32 s55, s62, 45056
  s_mov_b32 m0, s55
  s_nop 0
  buffer_load_dwordx4 v177, s[32:35], s37 offen lds
  s_add_u32 s36, s36, s38
  s_add_u32 s37, s37, s38
  ds_read_b64_tr_b16 v[248:249], v176 offset:58880
  ds_read_b64_tr_b16 v[250:251], v176 offset:59136
  ds_read_b64_tr_b16 v[252:253], v176 offset:62976
  ds_read_b64_tr_b16 v[254:255], v176 offset:63232
  s_waitcnt lgkmcnt(12)
  v_mfma_f32_32x32x16_bf16 v[128:143], v[112:115], v[224:227], v[128:143]
  v_mfma_f32_32x32x16_bf16 v[144:159], v[112:115], v[228:231], v[144:159]
  ds_read_b64_tr_b16 v[224:225], v187 offset:0
  ds_read_b64_tr_b16 v[226:227], v187 offset:256
  ds_read_b64_tr_b16 v[228:229], v187 offset:4096
  ds_read_b64_tr_b16 v[230:231], v187 offset:4352
  s_waitcnt lgkmcnt(12)
  v_mfma_f32_32x32x16_bf16 v[128:143], v[116:119], v[232:235], v[128:143]
  v_mfma_f32_32x32x16_bf16 v[144:159], v[116:119], v[236:239], v[144:159]
  ds_read_b64_tr_b16 v[232:233], v187 offset:512
  ds_read_b64_tr_b16 v[234:235], v187 offset:768
  ds_read_b64_tr_b16 v[236:237], v187 offset:4608
  ds_read_b64_tr_b16 v[238:239], v187 offset:4864
  s_waitcnt lgkmcnt(12)
  v_mfma_f32_32x32x16_bf16 v[128:143], v[120:123], v[240:243], v[128:143]
  v_mfma_f32_32x32x16_bf16 v[144:159], v[120:123], v[244:247], v[144:159]
  ds_read_b64_tr_b16 v[240:241], v187 offset:1024
  ds_read_b64_tr_b16 v[242:243], v187 offset:1280
  ds_read_b64_tr_b16 v[244:245], v187 offset:5120
  ds_read_b64_tr_b16 v[246:247], v187 offset:5376
  s_waitcnt lgkmcnt(12)
  v_mfma_f32_32x32x16_bf16 v[128:143], v[124:127], v[248:251], v[128:143]
  v_mfma_f32_32x32x16_bf16 v[144:159], v[124:127], v[252:255], v[144:159]
  s_sub_u32 s58, s7, 16
  s_lshl_b32 s58, s58, 18
  s_add_u32 s58, s58, 4194304
  s_nop 7
  v_cvt_pk_bf16_f32 v190, v128, v129
  v_cvt_pk_bf16_f32 v191, v130, v131
  v_cvt_pk_bf16_f32 v192, v136, v137
  v_cvt_pk_bf16_f32 v193, v138, v139
  v_cvt_pk_bf16_f32 v194, v132, v133
  v_cvt_pk_bf16_f32 v195, v134, v135
  v_cvt_pk_bf16_f32 v196, v140, v141
  v_cvt_pk_bf16_f32 v197, v142, v143
  s_add_u32 s59, s58, 0
  buffer_store_dwordx4 v[190:193], v185, s[24:27], s59 offen
  buffer_store_dwordx4 v[194:197], v185, s[24:27], s59 offen offset:32
  s_nop 0
  v_cvt_pk_bf16_f32 v190, v144, v145
  v_cvt_pk_bf16_f32 v191, v146, v147
  v_cvt_pk_bf16_f32 v192, v152, v153
  v_cvt_pk_bf16_f32 v193, v154, v155
  v_cvt_pk_bf16_f32 v194, v148, v149
  v_cvt_pk_bf16_f32 v195, v150, v151
  v_cvt_pk_bf16_f32 v196, v156, v157
  v_cvt_pk_bf16_f32 v197, v158, v159
  s_add_u32 s59, s58, 131072
  buffer_store_dwordx4 v[190:193], v185, s[24:27], s59 offen
  buffer_store_dwordx4 v[194:197], v185, s[24:27], s59 offen offset:32
L_k1_next:
  s_nop 7
  s_nop 4
  v_xor_b32 v176, 0x10000, v176
  v_xor_b32 v187, 0x10000, v187
  s_add_u32 s6, s6, 1
  s_add_u32 s7, s7, 1
  s_cmp_lt_u32 s6, 5
  s_cbranch_scc1 L_k1_tile
  s_waitcnt vmcnt(0)
L_k1_end:
  s_endpgm
.globl k2_kernel
.p2align 8
.type k2_kernel,@function
k2_kernel:
  s_cmp_ge_u32 s2, 512
  s_cbranch_scc1 L_k2_end
  s_load_dwordx2 s[4:5], s[0:1], 72
  v_and_b32 v192, 63, v0
  v_lshrrev_b32 v200, 6, v0
  s_nop 0
  v_readfirstlane_b32 s3, v200
  s_lshr_b32 s12, s2, 4
  s_and_b32 s13, s2, 15
  s_lshl_b32 s13, s13, 2
  s_add_u32 s13, s13, s3
  s_lshl_b32 s13, s13, 5
  v_and_b32 v193, 15, v192
  v_lshrrev_b32 v194, 4, v192
  s_waitcnt lgkmcnt(0)
  s_mov_b32 s8, s4
  s_and_b32 s9, s5, 0xffff
  s_mov_b32 s10, 0x1000000
  s_mov_b32 s11, 0x20000
  s_lshl_b32 s14, s12, 16
  s_sub_u32 s15, s13, 256
  v_lshlrev_b32 v200, 3, v194
  v_add_u32 v197, s13, v193
  v_lshlrev_b32 v197, 5, v197
  v_add_u32 v197, v197, v200
  v_add_u32 v195, s13, v193
  v_lshlrev_b32 v195, 5, v195
  v_add_u32 v195, v195, v200
  v_lshlrev_b32 v196, 12, v193
  v_lshlrev_b32 v200, 4, v194
  v_add_u32 v196, v196, v200
  s_lshl_b32 s16, s13, 1
  v_add_u32 v196, s16, v196
  s_add_u32 s17, s14, 0
  s_add_u32 s18, s14, 2088960
  s_add_u32 s19, s18, 4096
  s_add_u32 s20, s18, 8192
  s_add_u32 s21, s14, 4193792
  buffer_load_dwordx2 v[36:37], v197, s[8:11], s17 offen offset:0
  buffer_load_dwordx2 v[38:39], v197, s[8:11], s17 offen offset:512
  buffer_load_dwordx2 v[0:1], v195, s[8:11], s18 offen offset:0
  buffer_load_dwordx2 v[2:3], v195, s[8:11], s18 offen offset:512
  buffer_load_dwordx2 v[4:5], v195, s[8:11], s18 offen offset:1024
  buffer_load_dwordx2 v[6:7], v195, s[8:11], s18 offen offset:1536
  buffer_load_dwordx2 v[8:9], v195, s[8:11], s18 offen offset:2048
  buffer_load_dwordx2 v[10:11], v195, s[8:11], s18 offen offset:2560
  buffer_load_dwordx2 v[12:13], v195, s[8:11], s18 offen offset:3072
  buffer_load_dwordx2 v[14:15], v195, s[8:11], s18 offen offset:3584
  buffer_load_dwordx2 v[16:17], v195, s[8:11], s19 offen offset:0
  buffer_load_dwordx2 v[18:19], v195, s[8:11], s19 offen offset:512
  buffer_load_dwordx2 v[20:21], v195, s[8:11], s19 offen offset:1024
  buffer_load_dwordx2 v[22:23], v195, s[8:11], s19 offen offset:1536
  buffer_load_dwordx2 v[24:25], v195, s[8:11], s19 offen offset:2048
  buffer_load_dwordx2 v[26:27], v195, s[8:11], s19 offen offset:2560
  buffer_load_dwordx2 v[28:29], v195, s[8:11], s19 offen offset:3072
  buffer_load_dwordx2 v[30:31], v195, s[8:11], s19 offen offset:3584
  buffer_load_dwordx2 v[32:33], v195, s[8:11], s20 offen offset:0
  buffer_load_dwordx2 v[34:35], v195, s[8:11], s20 offen offset:512
  buffer_load_dwordx4 v[40:43], v196, s[8:11], s21 offen offset:0
  buffer_load_dwordx4 v[44:47], v196, s[8:11], s21 offen offset:64
  buffer_load_dwordx4 v[48:51], v196, s[8:11], s21 offen offset:128
  buffer_load_dwordx4 v[52:55], v196, s[8:11], s21 offen offset:192
  buffer_load_dwordx4 v[56:59], v196, s[8:11], s21 offen offset:256
  buffer_load_dwordx4 v[60:63], v196, s[8:11], s21 offen offset:320
  buffer_load_dwordx4 v[64:67], v196, s[8:11], s21 offen offset:384
  buffer_load_dwordx4 v[68:71], v196, s[8:11], s21 offen offset:448
  buffer_load_dwordx4 v[72:75], v196, s[8:11], s21 offen offset:512
  v_mov_b32 v201, 0xf149f2ca
  v_lshlrev_b32 v200, 2, v194
  v_add_u32 v202, 0, v200
  v_cmp_gt_u32 vcc, v202, v193
  s_nop 1
  v_cndmask_b32 v184, v201, 0, vcc
  v_cndmask_b32 v188, 0, v201, vcc
  v_add_u32 v202, 1, v200
  v_cmp_gt_u32 vcc, v202, v193
  s_nop 1
  v_cndmask_b32 v185, v201, 0, vcc
  v_cndmask_b32 v189, 0, v201, vcc
  v_add_u32 v202, 2, v200
  v_cmp_gt_u32 vcc, v202, v193
  s_nop 1
  v_cndmask_b32 v186, v201, 0, vcc
  v_cndmask_b32 v190, 0, v201, vcc
  v_add_u32 v202, 3, v200
  v_cmp_gt_u32 vcc, v202, v193
  s_nop 1
  v_cndmask_b32 v187, v201, 0, vcc
  v_cndmask_b32 v191, 0, v201, vcc
  v_add_u32 v198, s13, v193
  v_lshlrev_b32 v198, 10, v198
  v_lshlrev_b32 v200, 3, v194
  v_add_u32 v198, v198, v200
  s_lshl_b32 s22, s12, 5
  s_add_u32 s22, s22, 14680064
  s_add_u32 s23, s22, 16384
  s_sub_u32 s24, 256, s13
  s_max_i32 s24, s24, 0
  s_lshr_b32 s24, s24, 4
  s_mov_b32 s25, 0x3eb8aa3b
  s_cmp_lt_u32 s13, 256
  s_cbranch_scc1 L_k2_edge
  v_mov_b32 v144, 0
  v_mov_b32 v145, 0
  v_mov_b32 v178, 0
  v_mov_b32 v179, 0
  s_waitcnt vmcnt(9)
  v_mfma_f32_16x16x16_bf16 v[76:79], v[0:1], v[36:37], v[184:187]
  v_mfma_f32_16x16x16_bf16 v[80:83], v[2:3], v[36:37], 0
  v_mfma_f32_16x16x16_bf16 v[84:87], v[4:5], v[36:37], 0
  v_mfma_f32_16x16x16_bf16 v[88:91], v[6:7], v[36:37], 0
  v_mfma_f32_16x16x16_bf16 v[92:95], v[8:9], v[36:37], 0
  v_mfma_f32_16x16x16_bf16 v[96:99], v[10:11], v[36:37], 0
  v_mfma_f32_16x16x16_bf16 v[100:103], v[12:13], v[36:37], 0
  v_mfma_f32_16x16x16_bf16 v[104:107], v[14:15], v[36:37], 0
  v_mfma_f32_16x16x16_bf16 v[108:111], v[16:17], v[36:37], 0
  v_mfma_f32_16x16x16_bf16 v[112:115], v[18:19], v[36:37], 0
  v_mfma_f32_16x16x16_bf16 v[116:119], v[20:21], v[36:37], 0
  v_mfma_f32_16x16x16_bf16 v[120:123], v[22:23], v[36:37], 0
  v_mfma_f32_16x16x16_bf16 v[124:127], v[24:25], v[36:37], 0
  v_mfma_f32_16x16x16_bf16 v[128:131], v[26:27], v[36:37], 0
  v_mfma_f32_16x16x16_bf16 v[132:135], v[28:29], v[36:37], 0
  v_mfma_f32_16x16x16_bf16 v[136:139], v[30:31], v[36:37], 0
  v_mfma_f32_16x16x16_bf16 v[140:143], v[32:33], v[36:37], v[188:191]
  v_max3_f32 v200, v76, v77, v78
  v_max3_f32 v201, v79, v80, v81
  v_max3_f32 v200, v200, v82, v83
  v_max3_f32 v201, v201, v84, v85
  v_max3_f32 v200, v200, v86, v87
  v_max3_f32 v201, v201, v88, v89
  v_max3_f32 v200, v200, v90, v91
  v_max3_f32 v201, v201, v92, v93
  v_max3_f32 v200, v200, v94, v95
  v_max3_f32 v201, v201, v96, v97
  v_max3_f32 v200, v200, v98, v99
  v_max3_f32 v201, v201, v100, v101
  v_max3_f32 v200, v200, v102, v103
  v_max3_f32 v201, v201, v104, v105
  v_max3_f32 v200, v200, v106, v107
  v_max3_f32 v201, v201, v108, v109
  v_max3_f32 v200, v200, v110, v111
  v_max3_f32 v201, v201, v112, v113
  v_max3_f32 v200, v200, v114, v115
  v_max3_f32 v201, v201, v116, v117
  v_max3_f32 v200, v200, v118, v119
  v_max3_f32 v201, v201, v120, v121
  v_max3_f32 v200, v200, v122, v123
  v_max3_f32 v201, v201, v124, v125
  v_max3_f32 v200, v200, v126, v127
  v_max3_f32 v201, v201, v128, v129
  v_max3_f32 v200, v200, v130, v131
  v_max3_f32 v201, v201, v132, v133
  v_max3_f32 v200, v200, v134, v135
  v_max3_f32 v201, v201, v136, v137
  v_max3_f32 v200, v200, v138, v139
  v_max3_f32 v201, v201, v140, v141
  v_max3_f32 v200, v200, v142, v143
  v_max_f32 v200, v200, v201
  v_mov_b32 v201, v200
  s_nop 1
  v_permlane16_swap_b32 v200, v201
  v_max_f32 v200, v200, v201
  v_mov_b32 v201, v200
  s_nop 1
  v_permlane32_swap_b32 v200, v201
  v_max_f32 v200, v200, v201
  v_mul_f32 v200, s25, v200
  v_sub_f32 v200, 0, v200
  v_fma_f32 v76, v76, s25, v200
  v_fma_f32 v77, v77, s25, v200
  v_fma_f32 v78, v78, s25, v200
  v_fma_f32 v79, v79, s25, v200
  v_fma_f32 v80, v80, s25, v200
  v_fma_f32 v81, v81, s25, v200
  v_fma_f32 v82, v82, s25, v200
  v_fma_f32 v83, v83, s25, v200
  v_fma_f32 v84, v84, s25, v200
  v_fma_f32 v85, v85, s25, v200
  v_fma_f32 v86, v86, s25, v200
  v_fma_f32 v87, v87, s25, v200
  v_fma_f32 v88, v88, s25, v200
  v_fma_f32 v89, v89, s25, v200
  v_fma_f32 v90, v90, s25, v200
  v_fma_f32 v91, v91, s25, v200
  v_fma_f32 v92, v92, s25, v200
  v_fma_f32 v93, v93, s25, v200
  v_fma_f32 v94, v94, s25, v200
  v_fma_f32 v95, v95, s25, v200
  v_fma_f32 v96, v96, s25, v200
  v_fma_f32 v97, v97, s25, v200
  v_fma_f32 v98, v98, s25, v200
  v_fma_f32 v99, v99, s25, v200
  v_fma_f32 v100, v100, s25, v200
  v_fma_f32 v101, v101, s25, v200
  v_fma_f32 v102, v102, s25, v200
  v_fma_f32 v103, v103, s25, v200
  v_fma_f32 v104, v104, s25, v200
  v_fma_f32 v105, v105, s25, v200
  v_fma_f32 v106, v106, s25, v200
  v_fma_f32 v107, v107, s25, v200
  v_fma_f32 v108, v108, s25, v200
  v_fma_f32 v109, v109, s25, v200
  v_fma_f32 v110, v110, s25, v200
  v_fma_f32 v111, v111, s25, v200
  v_fma_f32 v112, v112, s25, v200
  v_fma_f32 v113, v113, s25, v200
  v_fma_f32 v114, v114, s25, v200
  v_fma_f32 v115, v115, s25, v200
  v_fma_f32 v116, v116, s25, v200
  v_fma_f32 v117, v117, s25, v200
  v_fma_f32 v118, v118, s25, v200
  v_fma_f32 v119, v119, s25, v200
  v_fma_f32 v120, v120, s25, v200
  v_fma_f32 v121, v121, s25, v200
  v_fma_f32 v122, v122, s25, v200
  v_fma_f32 v123, v123, s25, v200
  v_fma_f32 v124, v124, s25, v200
  v_fma_f32 v125, v125, s25, v200
  v_fma_f32 v126, v126, s25, v200
  v_fma_f32 v127, v127, s25, v200
  v_fma_f32 v128, v128, s25, v200
  v_fma_f32 v129, v129, s25, v200
  v_fma_f32 v130, v130, s25, v200
  v_fma_f32 v131, v131, s25, v200
  v_fma_f32 v132, v132, s25, v200
  v_fma_f32 v133, v133, s25, v200
  v_fma_f32 v134, v134, s25, v200
  v_fma_f32 v135, v135, s25, v200
  v_fma_f32 v136, v136, s25, v200
  v_fma_f32 v137, v137, s25, v200
  v_fma_f32 v138, v138, s25, v200
  v_fma_f32 v139, v139, s25, v200
  v_fma_f32 v140, v140, s25, v200
  v_fma_f32 v141, v141, s25, v200
  v_fma_f32 v142, v142, s25, v200
  v_fma_f32 v143, v143, s25, v200
  v_exp_f32 v76, v76
  v_exp_f32 v77, v77
  v_exp_f32 v78, v78
  v_exp_f32 v79, v79
  v_exp_f32 v80, v80
  v_exp_f32 v81, v81
  v_exp_f32 v82, v82
  v_exp_f32 v83, v83
  v_exp_f32 v84, v84
  v_exp_f32 v85, v85
  v_exp_f32 v86, v86
  v_exp_f32 v87, v87
  v_exp_f32 v88, v88
  v_exp_f32 v89, v89
  v_exp_f32 v90, v90
  v_exp_f32 v91, v91
  v_exp_f32 v92, v92
  v_exp_f32 v93, v93
  v_exp_f32 v94, v94
  v_exp_f32 v95, v95
  v_exp_f32 v96, v96
  v_exp_f32 v97, v97
  v_exp_f32 v98, v98
  v_exp_f32 v99, v99
  v_exp_f32 v100, v100
  v_exp_f32 v101, v101
  v_exp_f32 v102, v102
  v_exp_f32 v103, v103
  v_exp_f32 v104, v104
  v_exp_f32 v105, v105
  v_exp_f32 v106, v106
  v_exp_f32 v107, v107
  v_exp_f32 v108, v108
  v_exp_f32 v109, v109
  v_exp_f32 v110, v110
  v_exp_f32 v111, v111
  v_exp_f32 v112, v112
  v_exp_f32 v113, v113
  v_exp_f32 v114, v114
  v_exp_f32 v115, v115
  v_exp_f32 v116, v116
  v_exp_f32 v117, v117
  v_exp_f32 v118, v118
  v_exp_f32 v119, v119
  v_exp_f32 v120, v120
  v_exp_f32 v121, v121
  v_exp_f32 v122, v122
  v_exp_f32 v123, v123
  v_exp_f32 v124, v124
  v_exp_f32 v125, v125
  v_exp_f32 v126, v126
  v_exp_f32 v127, v127
  v_exp_f32 v128, v128
  v_exp_f32 v129, v129
  v_exp_f32 v130, v130
  v_exp_f32 v131, v131
  v_exp_f32 v132, v132
  v_exp_f32 v133, v133
  v_exp_f32 v134, v134
  v_exp_f32 v135, v135
  v_exp_f32 v136, v136
  v_exp_f32 v137, v137
  v_exp_f32 v138, v138
  v_exp_f32 v139, v139
  v_exp_f32 v140, v140
  v_exp_f32 v141, v141
  v_exp_f32 v142, v142
  v_exp_f32 v143, v143
  v_add_f32 v202, v76, v80
  v_add_f32 v203, v77, v81
  v_add_f32 v204, v78, v82
  v_add_f32 v205, v79, v83
  v_add_f32 v202, v202, v84
  v_add_f32 v203, v203, v85
  v_add_f32 v204, v204, v86
  v_add_f32 v205, v205, v87
  v_add_f32 v202, v202, v88
  v_add_f32 v203, v203, v89
  v_add_f32 v204, v204, v90
  v_add_f32 v205, v205, v91
  v_add_f32 v202, v202, v92
  v_add_f32 v203, v203, v93
  v_add_f32 v204, v204, v94
  v_add_f32 v205, v205, v95
  v_add_f32 v202, v202, v96
  v_add_f32 v203, v203, v97
  v_add_f32 v204, v204, v98
  v_add_f32 v205, v205, v99
  v_add_f32 v202, v202, v100
  v_add_f32 v203, v203, v101
  v_add_f32 v204, v204, v102
  v_add_f32 v205, v205, v103
  v_add_f32 v202, v202, v104
  v_add_f32 v203, v203, v105
  v_add_f32 v204, v204, v106
  v_add_f32 v205, v205, v107
  v_add_f32 v202, v202, v108
  v_add_f32 v203, v203, v109
  v_add_f32 v204, v204, v110
  v_add_f32 v205, v205, v111
  v_add_f32 v202, v202, v112
  v_add_f32 v203, v203, v113
  v_add_f32 v204, v204, v114
  v_add_f32 v205, v205, v115
  v_add_f32 v202, v202, v116
  v_add_f32 v203, v203, v117
  v_add_f32 v204, v204, v118
  v_add_f32 v205, v205, v119
  v_add_f32 v202, v202, v120
  v_add_f32 v203, v203, v121
  v_add_f32 v204, v204, v122
  v_add_f32 v205, v205, v123
  v_add_f32 v202, v202, v124
  v_add_f32 v203, v203, v125
  v_add_f32 v204, v204, v126
  v_add_f32 v205, v205, v127
  v_add_f32 v202, v202, v128
  v_add_f32 v203, v203, v129
  v_add_f32 v204, v204, v130
  v_add_f32 v205, v205, v131
  v_add_f32 v202, v202, v132
  v_add_f32 v203, v203, v133
  v_add_f32 v204, v204, v134
  v_add_f32 v205, v205, v135
  v_add_f32 v202, v202, v136
  v_add_f32 v203, v203, v137
  v_add_f32 v204, v204, v138
  v_add_f32 v205, v205, v139
  v_add_f32 v202, v202, v140
  v_add_f32 v203, v203, v141
  v_add_f32 v204, v204, v142
  v_add_f32 v205, v205, v143
  v_cvt_pk_bf16_f32 v144, v76, v77
  v_cvt_pk_bf16_f32 v145, v78, v79
  v_cvt_pk_bf16_f32 v146, v80, v81
  v_cvt_pk_bf16_f32 v147, v82, v83
  v_cvt_pk_bf16_f32 v148, v84, v85
  v_cvt_pk_bf16_f32 v149, v86, v87
  v_cvt_pk_bf16_f32 v150, v88, v89
  v_cvt_pk_bf16_f32 v151, v90, v91
  v_cvt_pk_bf16_f32 v152, v92, v93
  v_cvt_pk_bf16_f32 v153, v94, v95
  v_cvt_pk_bf16_f32 v154, v96, v97
  v_cvt_pk_bf16_f32 v155, v98, v99
  v_cvt_pk_bf16_f32 v156, v100, v101
  v_cvt_pk_bf16_f32 v157, v102, v103
  v_cvt_pk_bf16_f32 v158, v104, v105
  v_cvt_pk_bf16_f32 v159, v106, v107
  v_cvt_pk_bf16_f32 v160, v108, v109
  v_cvt_pk_bf16_f32 v161, v110, v111
  v_cvt_pk_bf16_f32 v162, v112, v113
  v_cvt_pk_bf16_f32 v163, v114, v115
  v_cvt_pk_bf16_f32 v164, v116, v117
  v_cvt_pk_bf16_f32 v165, v118, v119
  v_cvt_pk_bf16_f32 v166, v120, v121
  v_cvt_pk_bf16_f32 v167, v122, v123
  v_cvt_pk_bf16_f32 v168, v124, v125
  v_cvt_pk_bf16_f32 v169, v126, v127
  v_cvt_pk_bf16_f32 v170, v128, v129
  v_cvt_pk_bf16_f32 v171, v130, v131
  v_cvt_pk_bf16_f32 v172, v132, v133
  v_cvt_pk_bf16_f32 v173, v134, v135
  v_cvt_pk_bf16_f32 v174, v136, v137
  v_cvt_pk_bf16_f32 v175, v138, v139
  v_cvt_pk_bf16_f32 v176, v140, v141
  v_cvt_pk_bf16_f32 v177, v142, v143
  v_add_f32 v202, v202, v203
  v_add_f32 v204, v204, v205
  v_add_f32 v202, v202, v204
  v_mov_b32 v203, v202
  s_nop 1
  v_permlane16_swap_b32 v202, v203
  v_add_f32 v202, v202, v203
  v_mov_b32 v203, v202
  s_nop 1
  v_permlane32_swap_b32 v202, v203
  v_add_f32 v202, v202, v203
  v_rcp_f32 v202, v202
  s_waitcnt vmcnt(0)
  v_mfma_f32_16x16x32_bf16 v[180:183], v[40:43], v[144:147], 0
  v_mfma_f32_16x16x32_bf16 v[180:183], v[44:47], v[148:151], v[180:183]
  v_mfma_f32_16x16x32_bf16 v[180:183], v[48:51], v[152:155], v[180:183]
  v_mfma_f32_16x16x32_bf16 v[180:183], v[52:55], v[156:159], v[180:183]
  v_mfma_f32_16x16x32_bf16 v[180:183], v[56:59], v[160:163], v[180:183]
  v_mfma_f32_16x16x32_bf16 v[180:183], v[60:63], v[164:167], v[180:183]
  v_mfma_f32_16x16x32_bf16 v[180:183], v[64:67], v[168:171], v[180:183]
  v_mfma_f32_16x16x32_bf16 v[180:183], v[68:71], v[172:175], v[180:183]
  v_mfma_f32_16x16x32_bf16 v[180:183], v[72:75], v[176:179], v[180:183]
  s_nop 7
  v_mul_f32 v208, v202, v180
  v_mul_f32 v209, v202, v181
  v_mul_f32 v210, v202, v182
  v_mul_f32 v211, v202, v183
  v_cvt_pk_bf16_f32 v212, v208, v209
  v_cvt_pk_bf16_f32 v213, v210, v211
  buffer_store_dwordx2 v[212:213], v198, s[8:11], s22 offen
  v_mov_b32 v144, 0
  v_mov_b32 v145, 0
  v_mfma_f32_16x16x16_bf16 v[76:79], v[2:3], v[38:39], v[184:187]
  v_mfma_f32_16x16x16_bf16 v[80:83], v[4:5], v[38:39], 0
  v_mfma_f32_16x16x16_bf16 v[84:87], v[6:7], v[38:39], 0
  v_mfma_f32_16x16x16_bf16 v[88:91], v[8:9], v[38:39], 0
  v_mfma_f32_16x16x16_bf16 v[92:95], v[10:11], v[38:39], 0
  v_mfma_f32_16x16x16_bf16 v[96:99], v[12:13], v[38:39], 0
  v_mfma_f32_16x16x16_bf16 v[100:103], v[14:15], v[38:39], 0
  v_mfma_f32_16x16x16_bf16 v[104:107], v[16:17], v[38:39], 0
  v_mfma_f32_16x16x16_bf16 v[108:111], v[18:19], v[38:39], 0
  v_mfma_f32_16x16x16_bf16 v[112:115], v[20:21], v[38:39], 0
  v_mfma_f32_16x16x16_bf16 v[116:119], v[22:23], v[38:39], 0
  v_mfma_f32_16x16x16_bf16 v[120:123], v[24:25], v[38:39], 0
  v_mfma_f32_16x16x16_bf16 v[124:127], v[26:27], v[38:39], 0
  v_mfma_f32_16x16x16_bf16 v[128:131], v[28:29], v[38:39], 0
  v_mfma_f32_16x16x16_bf16 v[132:135], v[30:31], v[38:39], 0
  v_mfma_f32_16x16x16_bf16 v[136:139], v[32:33], v[38:39], 0
  v_mfma_f32_16x16x16_bf16 v[140:143], v[34:35], v[38:39], v[188:191]
  v_max3_f32 v200, v76, v77, v78
  v_max3_f32 v201, v79, v80, v81
  v_max3_f32 v200, v200, v82, v83
  v_max3_f32 v201, v201, v84, v85
  v_max3_f32 v200, v200, v86, v87
  v_max3_f32 v201, v201, v88, v89
  v_max3_f32 v200, v200, v90, v91
  v_max3_f32 v201, v201, v92, v93
  v_max3_f32 v200, v200, v94, v95
  v_max3_f32 v201, v201, v96, v97
  v_max3_f32 v200, v200, v98, v99
  v_max3_f32 v201, v201, v100, v101
  v_max3_f32 v200, v200, v102, v103
  v_max3_f32 v201, v201, v104, v105
  v_max3_f32 v200, v200, v106, v107
  v_max3_f32 v201, v201, v108, v109
  v_max3_f32 v200, v200, v110, v111
  v_max3_f32 v201, v201, v112, v113
  v_max3_f32 v200, v200, v114, v115
  v_max3_f32 v201, v201, v116, v117
  v_max3_f32 v200, v200, v118, v119
  v_max3_f32 v201, v201, v120, v121
  v_max3_f32 v200, v200, v122, v123
  v_max3_f32 v201, v201, v124, v125
  v_max3_f32 v200, v200, v126, v127
  v_max3_f32 v201, v201, v128, v129
  v_max3_f32 v200, v200, v130, v131
  v_max3_f32 v201, v201, v132, v133
  v_max3_f32 v200, v200, v134, v135
  v_max3_f32 v201, v201, v136, v137
  v_max3_f32 v200, v200, v138, v139
  v_max3_f32 v201, v201, v140, v141
  v_max3_f32 v200, v200, v142, v143
  v_max_f32 v200, v200, v201
  v_mov_b32 v201, v200
  s_nop 1
  v_permlane16_swap_b32 v200, v201
  v_max_f32 v200, v200, v201
  v_mov_b32 v201, v200
  s_nop 1
  v_permlane32_swap_b32 v200, v201
  v_max_f32 v200, v200, v201
  v_mul_f32 v200, s25, v200
  v_sub_f32 v200, 0, v200
  v_fma_f32 v76, v76, s25, v200
  v_fma_f32 v77, v77, s25, v200
  v_fma_f32 v78, v78, s25, v200
  v_fma_f32 v79, v79, s25, v200
  v_fma_f32 v80, v80, s25, v200
  v_fma_f32 v81, v81, s25, v200
  v_fma_f32 v82, v82, s25, v200
  v_fma_f32 v83, v83, s25, v200
  v_fma_f32 v84, v84, s25, v200
  v_fma_f32 v85, v85, s25, v200
  v_fma_f32 v86, v86, s25, v200
  v_fma_f32 v87, v87, s25, v200
  v_fma_f32 v88, v88, s25, v200
  v_fma_f32 v89, v89, s25, v200
  v_fma_f32 v90, v90, s25, v200
  v_fma_f32 v91, v91, s25, v200
  v_fma_f32 v92, v92, s25, v200
  v_fma_f32 v93, v93, s25, v200
  v_fma_f32 v94, v94, s25, v200
  v_fma_f32 v95, v95, s25, v200
  v_fma_f32 v96, v96, s25, v200
  v_fma_f32 v97, v97, s25, v200
  v_fma_f32 v98, v98, s25, v200
  v_fma_f32 v99, v99, s25, v200
  v_fma_f32 v100, v100, s25, v200
  v_fma_f32 v101, v101, s25, v200
  v_fma_f32 v102, v102, s25, v200
  v_fma_f32 v103, v103, s25, v200
  v_fma_f32 v104, v104, s25, v200
  v_fma_f32 v105, v105, s25, v200
  v_fma_f32 v106, v106, s25, v200
  v_fma_f32 v107, v107, s25, v200
  v_fma_f32 v108, v108, s25, v200
  v_fma_f32 v109, v109, s25, v200
  v_fma_f32 v110, v110, s25, v200
  v_fma_f32 v111, v111, s25, v200
  v_fma_f32 v112, v112, s25, v200
  v_fma_f32 v113, v113, s25, v200
  v_fma_f32 v114, v114, s25, v200
  v_fma_f32 v115, v115, s25, v200
  v_fma_f32 v116, v116, s25, v200
  v_fma_f32 v117, v117, s25, v200
  v_fma_f32 v118, v118, s25, v200
  v_fma_f32 v119, v119, s25, v200
  v_fma_f32 v120, v120, s25, v200
  v_fma_f32 v121, v121, s25, v200
  v_fma_f32 v122, v122, s25, v200
  v_fma_f32 v123, v123, s25, v200
  v_fma_f32 v124, v124, s25, v200
  v_fma_f32 v125, v125, s25, v200
  v_fma_f32 v126, v126, s25, v200
  v_fma_f32 v127, v127, s25, v200
  v_fma_f32 v128, v128, s25, v200
  v_fma_f32 v129, v129, s25, v200
  v_fma_f32 v130, v130, s25, v200
  v_fma_f32 v131, v131, s25, v200
  v_fma_f32 v132, v132, s25, v200
  v_fma_f32 v133, v133, s25, v200
  v_fma_f32 v134, v134, s25, v200
  v_fma_f32 v135, v135, s25, v200
  v_fma_f32 v136, v136, s25, v200
  v_fma_f32 v137, v137, s25, v200
  v_fma_f32 v138, v138, s25, v200
  v_fma_f32 v139, v139, s25, v200
  v_fma_f32 v140, v140, s25, v200
  v_fma_f32 v141, v141, s25, v200
  v_fma_f32 v142, v142, s25, v200
  v_fma_f32 v143, v143, s25, v200
  v_exp_f32 v76, v76
  v_exp_f32 v77, v77
  v_exp_f32 v78, v78
  v_exp_f32 v79, v79
  v_exp_f32 v80, v80
  v_exp_f32 v81, v81
  v_exp_f32 v82, v82
  v_exp_f32 v83, v83
  v_exp_f32 v84, v84
  v_exp_f32 v85, v85
  v_exp_f32 v86, v86
  v_exp_f32 v87, v87
  v_exp_f32 v88, v88
  v_exp_f32 v89, v89
  v_exp_f32 v90, v90
  v_exp_f32 v91, v91
  v_exp_f32 v92, v92
  v_exp_f32 v93, v93
  v_exp_f32 v94, v94
  v_exp_f32 v95, v95
  v_exp_f32 v96, v96
  v_exp_f32 v97, v97
  v_exp_f32 v98, v98
  v_exp_f32 v99, v99
  v_exp_f32 v100, v100
  v_exp_f32 v101, v101
  v_exp_f32 v102, v102
  v_exp_f32 v103, v103
  v_exp_f32 v104, v104
  v_exp_f32 v105, v105
  v_exp_f32 v106, v106
  v_exp_f32 v107, v107
  v_exp_f32 v108, v108
  v_exp_f32 v109, v109
  v_exp_f32 v110, v110
  v_exp_f32 v111, v111
  v_exp_f32 v112, v112
  v_exp_f32 v113, v113
  v_exp_f32 v114, v114
  v_exp_f32 v115, v115
  v_exp_f32 v116, v116
  v_exp_f32 v117, v117
  v_exp_f32 v118, v118
  v_exp_f32 v119, v119
  v_exp_f32 v120, v120
  v_exp_f32 v121, v121
  v_exp_f32 v122, v122
  v_exp_f32 v123, v123
  v_exp_f32 v124, v124
  v_exp_f32 v125, v125
  v_exp_f32 v126, v126
  v_exp_f32 v127, v127
  v_exp_f32 v128, v128
  v_exp_f32 v129, v129
  v_exp_f32 v130, v130
  v_exp_f32 v131, v131
  v_exp_f32 v132, v132
  v_exp_f32 v133, v133
  v_exp_f32 v134, v134
  v_exp_f32 v135, v135
  v_exp_f32 v136, v136
  v_exp_f32 v137, v137
  v_exp_f32 v138, v138
  v_exp_f32 v139, v139
  v_exp_f32 v140, v140
  v_exp_f32 v141, v141
  v_exp_f32 v142, v142
  v_exp_f32 v143, v143
  v_add_f32 v202, v76, v80
  v_add_f32 v203, v77, v81
  v_add_f32 v204, v78, v82
  v_add_f32 v205, v79, v83
  v_add_f32 v202, v202, v84
  v_add_f32 v203, v203, v85
  v_add_f32 v204, v204, v86
  v_add_f32 v205, v205, v87
  v_add_f32 v202, v202, v88
  v_add_f32 v203, v203, v89
  v_add_f32 v204, v204, v90
  v_add_f32 v205, v205, v91
  v_add_f32 v202, v202, v92
  v_add_f32 v203, v203, v93
  v_add_f32 v204, v204, v94
  v_add_f32 v205, v205, v95
  v_add_f32 v202, v202, v96
  v_add_f32 v203, v203, v97
  v_add_f32 v204, v204, v98
  v_add_f32 v205, v205, v99
  v_add_f32 v202, v202, v100
  v_add_f32 v203, v203, v101
  v_add_f32 v204, v204, v102
  v_add_f32 v205, v205, v103
  v_add_f32 v202, v202, v104
  v_add_f32 v203, v203, v105
  v_add_f32 v204, v204, v106
  v_add_f32 v205, v205, v107
  v_add_f32 v202, v202, v108
  v_add_f32 v203, v203, v109
  v_add_f32 v204, v204, v110
  v_add_f32 v205, v205, v111
  v_add_f32 v202, v202, v112
  v_add_f32 v203, v203, v113
  v_add_f32 v204, v204, v114
  v_add_f32 v205, v205, v115
  v_add_f32 v202, v202, v116
  v_add_f32 v203, v203, v117
  v_add_f32 v204, v204, v118
  v_add_f32 v205, v205, v119
  v_add_f32 v202, v202, v120
  v_add_f32 v203, v203, v121
  v_add_f32 v204, v204, v122
  v_add_f32 v205, v205, v123
  v_add_f32 v202, v202, v124
  v_add_f32 v203, v203, v125
  v_add_f32 v204, v204, v126
  v_add_f32 v205, v205, v127
  v_add_f32 v202, v202, v128
  v_add_f32 v203, v203, v129
  v_add_f32 v204, v204, v130
  v_add_f32 v205, v205, v131
  v_add_f32 v202, v202, v132
  v_add_f32 v203, v203, v133
  v_add_f32 v204, v204, v134
  v_add_f32 v205, v205, v135
  v_add_f32 v202, v202, v136
  v_add_f32 v203, v203, v137
  v_add_f32 v204, v204, v138
  v_add_f32 v205, v205, v139
  v_add_f32 v202, v202, v140
  v_add_f32 v203, v203, v141
  v_add_f32 v204, v204, v142
  v_add_f32 v205, v205, v143
  v_cvt_pk_bf16_f32 v146, v76, v77
  v_cvt_pk_bf16_f32 v147, v78, v79
  v_cvt_pk_bf16_f32 v148, v80, v81
  v_cvt_pk_bf16_f32 v149, v82, v83
  v_cvt_pk_bf16_f32 v150, v84, v85
  v_cvt_pk_bf16_f32 v151, v86, v87
  v_cvt_pk_bf16_f32 v152, v88, v89
  v_cvt_pk_bf16_f32 v153, v90, v91
  v_cvt_pk_bf16_f32 v154, v92, v93
  v_cvt_pk_bf16_f32 v155, v94, v95
  v_cvt_pk_bf16_f32 v156, v96, v97
  v_cvt_pk_bf16_f32 v157, v98, v99
  v_cvt_pk_bf16_f32 v158, v100, v101
  v_cvt_pk_bf16_f32 v159, v102, v103
  v_cvt_pk_bf16_f32 v160, v104, v105
  v_cvt_pk_bf16_f32 v161, v106, v107
  v_cvt_pk_bf16_f32 v162, v108, v109
  v_cvt_pk_bf16_f32 v163, v110, v111
  v_cvt_pk_bf16_f32 v164, v112, v113
  v_cvt_pk_bf16_f32 v165, v114, v115
  v_cvt_pk_bf16_f32 v166, v116, v117
  v_cvt_pk_bf16_f32 v167, v118, v119
  v_cvt_pk_bf16_f32 v168, v120, v121
  v_cvt_pk_bf16_f32 v169, v122, v123
  v_cvt_pk_bf16_f32 v170, v124, v125
  v_cvt_pk_bf16_f32 v171, v126, v127
  v_cvt_pk_bf16_f32 v172, v128, v129
  v_cvt_pk_bf16_f32 v173, v130, v131
  v_cvt_pk_bf16_f32 v174, v132, v133
  v_cvt_pk_bf16_f32 v175, v134, v135
  v_cvt_pk_bf16_f32 v176, v136, v137
  v_cvt_pk_bf16_f32 v177, v138, v139
  v_cvt_pk_bf16_f32 v178, v140, v141
  v_cvt_pk_bf16_f32 v179, v142, v143
  v_add_f32 v202, v202, v203
  v_add_f32 v204, v204, v205
  v_add_f32 v202, v202, v204
  v_mov_b32 v203, v202
  s_nop 1
  v_permlane16_swap_b32 v202, v203
  v_add_f32 v202, v202, v203
  v_mov_b32 v203, v202
  s_nop 1
  v_permlane32_swap_b32 v202, v203
  v_add_f32 v202, v202, v203
  v_rcp_f32 v202, v202
  v_mfma_f32_16x16x32_bf16 v[180:183], v[40:43], v[144:147], 0
  v_mfma_f32_16x16x32_bf16 v[180:183], v[44:47], v[148:151], v[180:183]
  v_mfma_f32_16x16x32_bf16 v[180:183], v[48:51], v[152:155], v[180:183]
  v_mfma_f32_16x16x32_bf16 v[180:183], v[52:55], v[156:159], v[180:183]
  v_mfma_f32_16x16x32_bf16 v[180:183], v[56:59], v[160:163], v[180:183]
  v_mfma_f32_16x16x32_bf16 v[180:183], v[60:63], v[164:167], v[180:183]
  v_mfma_f32_16x16x32_bf16 v[180:183], v[64:67], v[168:171], v[180:183]
  v_mfma_f32_16x16x32_bf16 v[180:183], v[68:71], v[172:175], v[180:183]
  v_mfma_f32_16x16x32_bf16 v[180:183], v[72:75], v[176:179], v[180:183]
  s_nop 7
  v_mul_f32 v208, v202, v180
  v_mul_f32 v209, v202, v181
  v_mul_f32 v210, v202, v182
  v_mul_f32 v211, v202, v183
  v_cvt_pk_bf16_f32 v212, v208, v209
  v_cvt_pk_bf16_f32 v213, v210, v211
  buffer_store_dwordx2 v[212:213], v198, s[8:11], s23 offen
  s_branch L_k2_end
L_k2_edge:
  s_nop 7
  s_nop 4
  v_mov_b32 v144, 0
  v_mov_b32 v145, 0
  v_mov_b32 v178, 0
  v_mov_b32 v179, 0
  s_waitcnt vmcnt(9)
  v_mfma_f32_16x16x16_bf16 v[76:79], v[0:1], v[36:37], v[184:187]
  v_mfma_f32_16x16x16_bf16 v[80:83], v[2:3], v[36:37], 0
  v_mfma_f32_16x16x16_bf16 v[84:87], v[4:5], v[36:37], 0
  v_mfma_f32_16x16x16_bf16 v[88:91], v[6:7], v[36:37], 0
  v_mfma_f32_16x16x16_bf16 v[92:95], v[8:9], v[36:37], 0
  v_mfma_f32_16x16x16_bf16 v[96:99], v[10:11], v[36:37], 0
  v_mfma_f32_16x16x16_bf16 v[100:103], v[12:13], v[36:37], 0
  v_mfma_f32_16x16x16_bf16 v[104:107], v[14:15], v[36:37], 0
  v_mfma_f32_16x16x16_bf16 v[108:111], v[16:17], v[36:37], 0
  v_mfma_f32_16x16x16_bf16 v[112:115], v[18:19], v[36:37], 0
  v_mfma_f32_16x16x16_bf16 v[116:119], v[20:21], v[36:37], 0
  v_mfma_f32_16x16x16_bf16 v[120:123], v[22:23], v[36:37], 0
  v_mfma_f32_16x16x16_bf16 v[124:127], v[24:25], v[36:37], 0
  v_mfma_f32_16x16x16_bf16 v[128:131], v[26:27], v[36:37], 0
  v_mfma_f32_16x16x16_bf16 v[132:135], v[28:29], v[36:37], 0
  v_mfma_f32_16x16x16_bf16 v[136:139], v[30:31], v[36:37], 0
  v_mfma_f32_16x16x16_bf16 v[140:143], v[32:33], v[36:37], v[188:191]
  s_cmp_gt_u32 s24, 0
  s_cselect_b32 s26, 0xf149f2ca, 0
  v_add_f32 v76, s26, v76
  v_add_f32 v77, s26, v77
  v_add_f32 v78, s26, v78
  v_add_f32 v79, s26, v79
  s_cmp_gt_u32 s24, 1
  s_cselect_b32 s26, 0xf149f2ca, 0
  v_add_f32 v80, s26, v80
  v_add_f32 v81, s26, v81
  v_add_f32 v82, s26, v82
  v_add_f32 v83, s26, v83
  s_cmp_gt_u32 s24, 2
  s_cselect_b32 s26, 0xf149f2ca, 0
  v_add_f32 v84, s26, v84
  v_add_f32 v85, s26, v85
  v_add_f32 v86, s26, v86
  v_add_f32 v87, s26, v87
  s_cmp_gt_u32 s24, 3
  s_cselect_b32 s26, 0xf149f2ca, 0
  v_add_f32 v88, s26, v88
  v_add_f32 v89, s26, v89
  v_add_f32 v90, s26, v90
  v_add_f32 v91, s26, v91
  s_cmp_gt_u32 s24, 4
  s_cselect_b32 s26, 0xf149f2ca, 0
  v_add_f32 v92, s26, v92
  v_add_f32 v93, s26, v93
  v_add_f32 v94, s26, v94
  v_add_f32 v95, s26, v95
  s_cmp_gt_u32 s24, 5
  s_cselect_b32 s26, 0xf149f2ca, 0
  v_add_f32 v96, s26, v96
  v_add_f32 v97, s26, v97
  v_add_f32 v98, s26, v98
  v_add_f32 v99, s26, v99
  s_cmp_gt_u32 s24, 6
  s_cselect_b32 s26, 0xf149f2ca, 0
  v_add_f32 v100, s26, v100
  v_add_f32 v101, s26, v101
  v_add_f32 v102, s26, v102
  v_add_f32 v103, s26, v103
  s_cmp_gt_u32 s24, 7
  s_cselect_b32 s26, 0xf149f2ca, 0
  v_add_f32 v104, s26, v104
  v_add_f32 v105, s26, v105
  v_add_f32 v106, s26, v106
  v_add_f32 v107, s26, v107
  s_cmp_gt_u32 s24, 8
  s_cselect_b32 s26, 0xf149f2ca, 0
  v_add_f32 v108, s26, v108
  v_add_f32 v109, s26, v109
  v_add_f32 v110, s26, v110
  v_add_f32 v111, s26, v111
  s_cmp_gt_u32 s24, 9
  s_cselect_b32 s26, 0xf149f2ca, 0
  v_add_f32 v112, s26, v112
  v_add_f32 v113, s26, v113
  v_add_f32 v114, s26, v114
  v_add_f32 v115, s26, v115
  s_cmp_gt_u32 s24, 10
  s_cselect_b32 s26, 0xf149f2ca, 0
  v_add_f32 v116, s26, v116
  v_add_f32 v117, s26, v117
  v_add_f32 v118, s26, v118
  v_add_f32 v119, s26, v119
  s_cmp_gt_u32 s24, 11
  s_cselect_b32 s26, 0xf149f2ca, 0
  v_add_f32 v120, s26, v120
  v_add_f32 v121, s26, v121
  v_add_f32 v122, s26, v122
  v_add_f32 v123, s26, v123
  s_cmp_gt_u32 s24, 12
  s_cselect_b32 s26, 0xf149f2ca, 0
  v_add_f32 v124, s26, v124
  v_add_f32 v125, s26, v125
  v_add_f32 v126, s26, v126
  v_add_f32 v127, s26, v127
  s_cmp_gt_u32 s24, 13
  s_cselect_b32 s26, 0xf149f2ca, 0
  v_add_f32 v128, s26, v128
  v_add_f32 v129, s26, v129
  v_add_f32 v130, s26, v130
  v_add_f32 v131, s26, v131
  s_cmp_gt_u32 s24, 14
  s_cselect_b32 s26, 0xf149f2ca, 0
  v_add_f32 v132, s26, v132
  v_add_f32 v133, s26, v133
  v_add_f32 v134, s26, v134
  v_add_f32 v135, s26, v135
  s_cmp_gt_u32 s24, 15
  s_cselect_b32 s26, 0xf149f2ca, 0
  v_add_f32 v136, s26, v136
  v_add_f32 v137, s26, v137
  v_add_f32 v138, s26, v138
  v_add_f32 v139, s26, v139
  v_max3_f32 v200, v76, v77, v78
  v_max3_f32 v201, v79, v80, v81
  v_max3_f32 v200, v200, v82, v83
  v_max3_f32 v201, v201, v84, v85
  v_max3_f32 v200, v200, v86, v87
  v_max3_f32 v201, v201, v88, v89
  v_max3_f32 v200, v200, v90, v91
  v_max3_f32 v201, v201, v92, v93
  v_max3_f32 v200, v200, v94, v95
  v_max3_f32 v201, v201, v96, v97
  v_max3_f32 v200, v200, v98, v99
  v_max3_f32 v201, v201, v100, v101
  v_max3_f32 v200, v200, v102, v103
  v_max3_f32 v201, v201, v104, v105
  v_max3_f32 v200, v200, v106, v107
  v_max3_f32 v201, v201, v108, v109
  v_max3_f32 v200, v200, v110, v111
  v_max3_f32 v201, v201, v112, v113
  v_max3_f32 v200, v200, v114, v115
  v_max3_f32 v201, v201, v116, v117
  v_max3_f32 v200, v200, v118, v119
  v_max3_f32 v201, v201, v120, v121
  v_max3_f32 v200, v200, v122, v123
  v_max3_f32 v201, v201, v124, v125
  v_max3_f32 v200, v200, v126, v127
  v_max3_f32 v201, v201, v128, v129
  v_max3_f32 v200, v200, v130, v131
  v_max3_f32 v201, v201, v132, v133
  v_max3_f32 v200, v200, v134, v135
  v_max3_f32 v201, v201, v136, v137
  v_max3_f32 v200, v200, v138, v139
  v_max3_f32 v201, v201, v140, v141
  v_max3_f32 v200, v200, v142, v143
  v_max_f32 v200, v200, v201
  v_mov_b32 v201, v200
  s_nop 1
  v_permlane16_swap_b32 v200, v201
  v_max_f32 v200, v200, v201
  v_mov_b32 v201, v200
  s_nop 1
  v_permlane32_swap_b32 v200, v201
  v_max_f32 v200, v200, v201
  v_mul_f32 v200, s25, v200
  v_sub_f32 v200, 0, v200
  v_fma_f32 v76, v76, s25, v200
  v_fma_f32 v77, v77, s25, v200
  v_fma_f32 v78, v78, s25, v200
  v_fma_f32 v79, v79, s25, v200
  v_fma_f32 v80, v80, s25, v200
  v_fma_f32 v81, v81, s25, v200
  v_fma_f32 v82, v82, s25, v200
  v_fma_f32 v83, v83, s25, v200
  v_fma_f32 v84, v84, s25, v200
  v_fma_f32 v85, v85, s25, v200
  v_fma_f32 v86, v86, s25, v200
  v_fma_f32 v87, v87, s25, v200
  v_fma_f32 v88, v88, s25, v200
  v_fma_f32 v89, v89, s25, v200
  v_fma_f32 v90, v90, s25, v200
  v_fma_f32 v91, v91, s25, v200
  v_fma_f32 v92, v92, s25, v200
  v_fma_f32 v93, v93, s25, v200
  v_fma_f32 v94, v94, s25, v200
  v_fma_f32 v95, v95, s25, v200
  v_fma_f32 v96, v96, s25, v200
  v_fma_f32 v97, v97, s25, v200
  v_fma_f32 v98, v98, s25, v200
  v_fma_f32 v99, v99, s25, v200
  v_fma_f32 v100, v100, s25, v200
  v_fma_f32 v101, v101, s25, v200
  v_fma_f32 v102, v102, s25, v200
  v_fma_f32 v103, v103, s25, v200
  v_fma_f32 v104, v104, s25, v200
  v_fma_f32 v105, v105, s25, v200
  v_fma_f32 v106, v106, s25, v200
  v_fma_f32 v107, v107, s25, v200
  v_fma_f32 v108, v108, s25, v200
  v_fma_f32 v109, v109, s25, v200
  v_fma_f32 v110, v110, s25, v200
  v_fma_f32 v111, v111, s25, v200
  v_fma_f32 v112, v112, s25, v200
  v_fma_f32 v113, v113, s25, v200
  v_fma_f32 v114, v114, s25, v200
  v_fma_f32 v115, v115, s25, v200
  v_fma_f32 v116, v116, s25, v200
  v_fma_f32 v117, v117, s25, v200
  v_fma_f32 v118, v118, s25, v200
  v_fma_f32 v119, v119, s25, v200
  v_fma_f32 v120, v120, s25, v200
  v_fma_f32 v121, v121, s25, v200
  v_fma_f32 v122, v122, s25, v200
  v_fma_f32 v123, v123, s25, v200
  v_fma_f32 v124, v124, s25, v200
  v_fma_f32 v125, v125, s25, v200
  v_fma_f32 v126, v126, s25, v200
  v_fma_f32 v127, v127, s25, v200
  v_fma_f32 v128, v128, s25, v200
  v_fma_f32 v129, v129, s25, v200
  v_fma_f32 v130, v130, s25, v200
  v_fma_f32 v131, v131, s25, v200
  v_fma_f32 v132, v132, s25, v200
  v_fma_f32 v133, v133, s25, v200
  v_fma_f32 v134, v134, s25, v200
  v_fma_f32 v135, v135, s25, v200
  v_fma_f32 v136, v136, s25, v200
  v_fma_f32 v137, v137, s25, v200
  v_fma_f32 v138, v138, s25, v200
  v_fma_f32 v139, v139, s25, v200
  v_fma_f32 v140, v140, s25, v200
  v_fma_f32 v141, v141, s25, v200
  v_fma_f32 v142, v142, s25, v200
  v_fma_f32 v143, v143, s25, v200
  v_exp_f32 v76, v76
  v_exp_f32 v77, v77
  v_exp_f32 v78, v78
  v_exp_f32 v79, v79
  v_exp_f32 v80, v80
  v_exp_f32 v81, v81
  v_exp_f32 v82, v82
  v_exp_f32 v83, v83
  v_exp_f32 v84, v84
  v_exp_f32 v85, v85
  v_exp_f32 v86, v86
  v_exp_f32 v87, v87
  v_exp_f32 v88, v88
  v_exp_f32 v89, v89
  v_exp_f32 v90, v90
  v_exp_f32 v91, v91
  v_exp_f32 v92, v92
  v_exp_f32 v93, v93
  v_exp_f32 v94, v94
  v_exp_f32 v95, v95
  v_exp_f32 v96, v96
  v_exp_f32 v97, v97
  v_exp_f32 v98, v98
  v_exp_f32 v99, v99
  v_exp_f32 v100, v100
  v_exp_f32 v101, v101
  v_exp_f32 v102, v102
  v_exp_f32 v103, v103
  v_exp_f32 v104, v104
  v_exp_f32 v105, v105
  v_exp_f32 v106, v106
  v_exp_f32 v107, v107
  v_exp_f32 v108, v108
  v_exp_f32 v109, v109
  v_exp_f32 v110, v110
  v_exp_f32 v111, v111
  v_exp_f32 v112, v112
  v_exp_f32 v113, v113
  v_exp_f32 v114, v114
  v_exp_f32 v115, v115
  v_exp_f32 v116, v116
  v_exp_f32 v117, v117
  v_exp_f32 v118, v118
  v_exp_f32 v119, v119
  v_exp_f32 v120, v120
  v_exp_f32 v121, v121
  v_exp_f32 v122, v122
  v_exp_f32 v123, v123
  v_exp_f32 v124, v124
  v_exp_f32 v125, v125
  v_exp_f32 v126, v126
  v_exp_f32 v127, v127
  v_exp_f32 v128, v128
  v_exp_f32 v129, v129
  v_exp_f32 v130, v130
  v_exp_f32 v131, v131
  v_exp_f32 v132, v132
  v_exp_f32 v133, v133
  v_exp_f32 v134, v134
  v_exp_f32 v135, v135
  v_exp_f32 v136, v136
  v_exp_f32 v137, v137
  v_exp_f32 v138, v138
  v_exp_f32 v139, v139
  v_exp_f32 v140, v140
  v_exp_f32 v141, v141
  v_exp_f32 v142, v142
  v_exp_f32 v143, v143
  v_add_f32 v202, v76, v80
  v_add_f32 v203, v77, v81
  v_add_f32 v204, v78, v82
  v_add_f32 v205, v79, v83
  v_add_f32 v202, v202, v84
  v_add_f32 v203, v203, v85
  v_add_f32 v204, v204, v86
  v_add_f32 v205, v205, v87
  v_add_f32 v202, v202, v88
  v_add_f32 v203, v203, v89
  v_add_f32 v204, v204, v90
  v_add_f32 v205, v205, v91
  v_add_f32 v202, v202, v92
  v_add_f32 v203, v203, v93
  v_add_f32 v204, v204, v94
  v_add_f32 v205, v205, v95
  v_add_f32 v202, v202, v96
  v_add_f32 v203, v203, v97
  v_add_f32 v204, v204, v98
  v_add_f32 v205, v205, v99
  v_add_f32 v202, v202, v100
  v_add_f32 v203, v203, v101
  v_add_f32 v204, v204, v102
  v_add_f32 v205, v205, v103
  v_add_f32 v202, v202, v104
  v_add_f32 v203, v203, v105
  v_add_f32 v204, v204, v106
  v_add_f32 v205, v205, v107
  v_add_f32 v202, v202, v108
  v_add_f32 v203, v203, v109
  v_add_f32 v204, v204, v110
  v_add_f32 v205, v205, v111
  v_add_f32 v202, v202, v112
  v_add_f32 v203, v203, v113
  v_add_f32 v204, v204, v114
  v_add_f32 v205, v205, v115
  v_add_f32 v202, v202, v116
  v_add_f32 v203, v203, v117
  v_add_f32 v204, v204, v118
  v_add_f32 v205, v205, v119
  v_add_f32 v202, v202, v120
  v_add_f32 v203, v203, v121
  v_add_f32 v204, v204, v122
  v_add_f32 v205, v205, v123
  v_add_f32 v202, v202, v124
  v_add_f32 v203, v203, v125
  v_add_f32 v204, v204, v126
  v_add_f32 v205, v205, v127
  v_add_f32 v202, v202, v128
  v_add_f32 v203, v203, v129
  v_add_f32 v204, v204, v130
  v_add_f32 v205, v205, v131
  v_add_f32 v202, v202, v132
  v_add_f32 v203, v203, v133
  v_add_f32 v204, v204, v134
  v_add_f32 v205, v205, v135
  v_add_f32 v202, v202, v136
  v_add_f32 v203, v203, v137
  v_add_f32 v204, v204, v138
  v_add_f32 v205, v205, v139
  v_add_f32 v202, v202, v140
  v_add_f32 v203, v203, v141
  v_add_f32 v204, v204, v142
  v_add_f32 v205, v205, v143
  v_cvt_pk_bf16_f32 v144, v76, v77
  v_cvt_pk_bf16_f32 v145, v78, v79
  v_cvt_pk_bf16_f32 v146, v80, v81
  v_cvt_pk_bf16_f32 v147, v82, v83
  v_cvt_pk_bf16_f32 v148, v84, v85
  v_cvt_pk_bf16_f32 v149, v86, v87
  v_cvt_pk_bf16_f32 v150, v88, v89
  v_cvt_pk_bf16_f32 v151, v90, v91
  v_cvt_pk_bf16_f32 v152, v92, v93
  v_cvt_pk_bf16_f32 v153, v94, v95
  v_cvt_pk_bf16_f32 v154, v96, v97
  v_cvt_pk_bf16_f32 v155, v98, v99
  v_cvt_pk_bf16_f32 v156, v100, v101
  v_cvt_pk_bf16_f32 v157, v102, v103
  v_cvt_pk_bf16_f32 v158, v104, v105
  v_cvt_pk_bf16_f32 v159, v106, v107
  v_cvt_pk_bf16_f32 v160, v108, v109
  v_cvt_pk_bf16_f32 v161, v110, v111
  v_cvt_pk_bf16_f32 v162, v112, v113
  v_cvt_pk_bf16_f32 v163, v114, v115
  v_cvt_pk_bf16_f32 v164, v116, v117
  v_cvt_pk_bf16_f32 v165, v118, v119
  v_cvt_pk_bf16_f32 v166, v120, v121
  v_cvt_pk_bf16_f32 v167, v122, v123
  v_cvt_pk_bf16_f32 v168, v124, v125
  v_cvt_pk_bf16_f32 v169, v126, v127
  v_cvt_pk_bf16_f32 v170, v128, v129
  v_cvt_pk_bf16_f32 v171, v130, v131
  v_cvt_pk_bf16_f32 v172, v132, v133
  v_cvt_pk_bf16_f32 v173, v134, v135
  v_cvt_pk_bf16_f32 v174, v136, v137
  v_cvt_pk_bf16_f32 v175, v138, v139
  v_cvt_pk_bf16_f32 v176, v140, v141
  v_cvt_pk_bf16_f32 v177, v142, v143
  v_add_f32 v202, v202, v203
  v_add_f32 v204, v204, v205
  v_add_f32 v202, v202, v204
  v_mov_b32 v203, v202
  s_nop 1
  v_permlane16_swap_b32 v202, v203
  v_add_f32 v202, v202, v203
  v_mov_b32 v203, v202
  s_nop 1
  v_permlane32_swap_b32 v202, v203
  v_add_f32 v202, v202, v203
  v_rcp_f32 v202, v202
  s_waitcnt vmcnt(0)
  v_mfma_f32_16x16x32_bf16 v[180:183], v[40:43], v[144:147], 0
  v_mfma_f32_16x16x32_bf16 v[180:183], v[44:47], v[148:151], v[180:183]
  v_mfma_f32_16x16x32_bf16 v[180:183], v[48:51], v[152:155], v[180:183]
  v_mfma_f32_16x16x32_bf16 v[180:183], v[52:55], v[156:159], v[180:183]
  v_mfma_f32_16x16x32_bf16 v[180:183], v[56:59], v[160:163], v[180:183]
  v_mfma_f32_16x16x32_bf16 v[180:183], v[60:63], v[164:167], v[180:183]
  v_mfma_f32_16x16x32_bf16 v[180:183], v[64:67], v[168:171], v[180:183]
  v_mfma_f32_16x16x32_bf16 v[180:183], v[68:71], v[172:175], v[180:183]
  v_mfma_f32_16x16x32_bf16 v[180:183], v[72:75], v[176:179], v[180:183]
  s_nop 7
  v_mul_f32 v208, v202, v180
  v_mul_f32 v209, v202, v181
  v_mul_f32 v210, v202, v182
  v_mul_f32 v211, v202, v183
  v_cvt_pk_bf16_f32 v212, v208, v209
  v_cvt_pk_bf16_f32 v213, v210, v211
  buffer_store_dwordx2 v[212:213], v198, s[8:11], s22 offen
  v_mov_b32 v144, 0
  v_mov_b32 v145, 0
  v_mfma_f32_16x16x16_bf16 v[76:79], v[2:3], v[38:39], v[184:187]
  v_mfma_f32_16x16x16_bf16 v[80:83], v[4:5], v[38:39], 0
  v_mfma_f32_16x16x16_bf16 v[84:87], v[6:7], v[38:39], 0
  v_mfma_f32_16x16x16_bf16 v[88:91], v[8:9], v[38:39], 0
  v_mfma_f32_16x16x16_bf16 v[92:95], v[10:11], v[38:39], 0
  v_mfma_f32_16x16x16_bf16 v[96:99], v[12:13], v[38:39], 0
  v_mfma_f32_16x16x16_bf16 v[100:103], v[14:15], v[38:39], 0
  v_mfma_f32_16x16x16_bf16 v[104:107], v[16:17], v[38:39], 0
  v_mfma_f32_16x16x16_bf16 v[108:111], v[18:19], v[38:39], 0
  v_mfma_f32_16x16x16_bf16 v[112:115], v[20:21], v[38:39], 0
  v_mfma_f32_16x16x16_bf16 v[116:119], v[22:23], v[38:39], 0
  v_mfma_f32_16x16x16_bf16 v[120:123], v[24:25], v[38:39], 0
  v_mfma_f32_16x16x16_bf16 v[124:127], v[26:27], v[38:39], 0
  v_mfma_f32_16x16x16_bf16 v[128:131], v[28:29], v[38:39], 0
  v_mfma_f32_16x16x16_bf16 v[132:135], v[30:31], v[38:39], 0
  v_mfma_f32_16x16x16_bf16 v[136:139], v[32:33], v[38:39], 0
  v_mfma_f32_16x16x16_bf16 v[140:143], v[34:35], v[38:39], v[188:191]
  s_cmp_gt_u32 s24, 1
  s_cselect_b32 s26, 0xf149f2ca, 0
  v_add_f32 v76, s26, v76
  v_add_f32 v77, s26, v77
  v_add_f32 v78, s26, v78
  v_add_f32 v79, s26, v79
  s_cmp_gt_u32 s24, 2
  s_cselect_b32 s26, 0xf149f2ca, 0
  v_add_f32 v80, s26, v80
  v_add_f32 v81, s26, v81
  v_add_f32 v82, s26, v82
  v_add_f32 v83, s26, v83
  s_cmp_gt_u32 s24, 3
  s_cselect_b32 s26, 0xf149f2ca, 0
  v_add_f32 v84, s26, v84
  v_add_f32 v85, s26, v85
  v_add_f32 v86, s26, v86
  v_add_f32 v87, s26, v87
  s_cmp_gt_u32 s24, 4
  s_cselect_b32 s26, 0xf149f2ca, 0
  v_add_f32 v88, s26, v88
  v_add_f32 v89, s26, v89
  v_add_f32 v90, s26, v90
  v_add_f32 v91, s26, v91
  s_cmp_gt_u32 s24, 5
  s_cselect_b32 s26, 0xf149f2ca, 0
  v_add_f32 v92, s26, v92
  v_add_f32 v93, s26, v93
  v_add_f32 v94, s26, v94
  v_add_f32 v95, s26, v95
  s_cmp_gt_u32 s24, 6
  s_cselect_b32 s26, 0xf149f2ca, 0
  v_add_f32 v96, s26, v96
  v_add_f32 v97, s26, v97
  v_add_f32 v98, s26, v98
  v_add_f32 v99, s26, v99
  s_cmp_gt_u32 s24, 7
  s_cselect_b32 s26, 0xf149f2ca, 0
  v_add_f32 v100, s26, v100
  v_add_f32 v101, s26, v101
  v_add_f32 v102, s26, v102
  v_add_f32 v103, s26, v103
  s_cmp_gt_u32 s24, 8
  s_cselect_b32 s26, 0xf149f2ca, 0
  v_add_f32 v104, s26, v104
  v_add_f32 v105, s26, v105
  v_add_f32 v106, s26, v106
  v_add_f32 v107, s26, v107
  s_cmp_gt_u32 s24, 9
  s_cselect_b32 s26, 0xf149f2ca, 0
  v_add_f32 v108, s26, v108
  v_add_f32 v109, s26, v109
  v_add_f32 v110, s26, v110
  v_add_f32 v111, s26, v111
  s_cmp_gt_u32 s24, 10
  s_cselect_b32 s26, 0xf149f2ca, 0
  v_add_f32 v112, s26, v112
  v_add_f32 v113, s26, v113
  v_add_f32 v114, s26, v114
  v_add_f32 v115, s26, v115
  s_cmp_gt_u32 s24, 11
  s_cselect_b32 s26, 0xf149f2ca, 0
  v_add_f32 v116, s26, v116
  v_add_f32 v117, s26, v117
  v_add_f32 v118, s26, v118
  v_add_f32 v119, s26, v119
  s_cmp_gt_u32 s24, 12
  s_cselect_b32 s26, 0xf149f2ca, 0
  v_add_f32 v120, s26, v120
  v_add_f32 v121, s26, v121
  v_add_f32 v122, s26, v122
  v_add_f32 v123, s26, v123
  s_cmp_gt_u32 s24, 13
  s_cselect_b32 s26, 0xf149f2ca, 0
  v_add_f32 v124, s26, v124
  v_add_f32 v125, s26, v125
  v_add_f32 v126, s26, v126
  v_add_f32 v127, s26, v127
  s_cmp_gt_u32 s24, 14
  s_cselect_b32 s26, 0xf149f2ca, 0
  v_add_f32 v128, s26, v128
  v_add_f32 v129, s26, v129
  v_add_f32 v130, s26, v130
  v_add_f32 v131, s26, v131
  s_cmp_gt_u32 s24, 15
  s_cselect_b32 s26, 0xf149f2ca, 0
  v_add_f32 v132, s26, v132
  v_add_f32 v133, s26, v133
  v_add_f32 v134, s26, v134
  v_add_f32 v135, s26, v135
  s_cmp_gt_u32 s24, 16
  s_cselect_b32 s26, 0xf149f2ca, 0
  v_add_f32 v136, s26, v136
  v_add_f32 v137, s26, v137
  v_add_f32 v138, s26, v138
  v_add_f32 v139, s26, v139
  v_max3_f32 v200, v76, v77, v78
  v_max3_f32 v201, v79, v80, v81
  v_max3_f32 v200, v200, v82, v83
  v_max3_f32 v201, v201, v84, v85
  v_max3_f32 v200, v200, v86, v87
  v_max3_f32 v201, v201, v88, v89
  v_max3_f32 v200, v200, v90, v91
  v_max3_f32 v201, v201, v92, v93
  v_max3_f32 v200, v200, v94, v95
  v_max3_f32 v201, v201, v96, v97
  v_max3_f32 v200, v200, v98, v99
  v_max3_f32 v201, v201, v100, v101
  v_max3_f32 v200, v200, v102, v103
  v_max3_f32 v201, v201, v104, v105
  v_max3_f32 v200, v200, v106, v107
  v_max3_f32 v201, v201, v108, v109
  v_max3_f32 v200, v200, v110, v111
  v_max3_f32 v201, v201, v112, v113
  v_max3_f32 v200, v200, v114, v115
  v_max3_f32 v201, v201, v116, v117
  v_max3_f32 v200, v200, v118, v119
  v_max3_f32 v201, v201, v120, v121
  v_max3_f32 v200, v200, v122, v123
  v_max3_f32 v201, v201, v124, v125
  v_max3_f32 v200, v200, v126, v127
  v_max3_f32 v201, v201, v128, v129
  v_max3_f32 v200, v200, v130, v131
  v_max3_f32 v201, v201, v132, v133
  v_max3_f32 v200, v200, v134, v135
  v_max3_f32 v201, v201, v136, v137
  v_max3_f32 v200, v200, v138, v139
  v_max3_f32 v201, v201, v140, v141
  v_max3_f32 v200, v200, v142, v143
  v_max_f32 v200, v200, v201
  v_mov_b32 v201, v200
  s_nop 1
  v_permlane16_swap_b32 v200, v201
  v_max_f32 v200, v200, v201
  v_mov_b32 v201, v200
  s_nop 1
  v_permlane32_swap_b32 v200, v201
  v_max_f32 v200, v200, v201
  v_mul_f32 v200, s25, v200
  v_sub_f32 v200, 0, v200
  v_fma_f32 v76, v76, s25, v200
  v_fma_f32 v77, v77, s25, v200
  v_fma_f32 v78, v78, s25, v200
  v_fma_f32 v79, v79, s25, v200
  v_fma_f32 v80, v80, s25, v200
  v_fma_f32 v81, v81, s25, v200
  v_fma_f32 v82, v82, s25, v200
  v_fma_f32 v83, v83, s25, v200
  v_fma_f32 v84, v84, s25, v200
  v_fma_f32 v85, v85, s25, v200
  v_fma_f32 v86, v86, s25, v200
  v_fma_f32 v87, v87, s25, v200
  v_fma_f32 v88, v88, s25, v200
  v_fma_f32 v89, v89, s25, v200
  v_fma_f32 v90, v90, s25, v200
  v_fma_f32 v91, v91, s25, v200
  v_fma_f32 v92, v92, s25, v200
  v_fma_f32 v93, v93, s25, v200
  v_fma_f32 v94, v94, s25, v200
  v_fma_f32 v95, v95, s25, v200
  v_fma_f32 v96, v96, s25, v200
  v_fma_f32 v97, v97, s25, v200
  v_fma_f32 v98, v98, s25, v200
  v_fma_f32 v99, v99, s25, v200
  v_fma_f32 v100, v100, s25, v200
  v_fma_f32 v101, v101, s25, v200
  v_fma_f32 v102, v102, s25, v200
  v_fma_f32 v103, v103, s25, v200
  v_fma_f32 v104, v104, s25, v200
  v_fma_f32 v105, v105, s25, v200
  v_fma_f32 v106, v106, s25, v200
  v_fma_f32 v107, v107, s25, v200
  v_fma_f32 v108, v108, s25, v200
  v_fma_f32 v109, v109, s25, v200
  v_fma_f32 v110, v110, s25, v200
  v_fma_f32 v111, v111, s25, v200
  v_fma_f32 v112, v112, s25, v200
  v_fma_f32 v113, v113, s25, v200
  v_fma_f32 v114, v114, s25, v200
  v_fma_f32 v115, v115, s25, v200
  v_fma_f32 v116, v116, s25, v200
  v_fma_f32 v117, v117, s25, v200
  v_fma_f32 v118, v118, s25, v200
  v_fma_f32 v119, v119, s25, v200
  v_fma_f32 v120, v120, s25, v200
  v_fma_f32 v121, v121, s25, v200
  v_fma_f32 v122, v122, s25, v200
  v_fma_f32 v123, v123, s25, v200
  v_fma_f32 v124, v124, s25, v200
  v_fma_f32 v125, v125, s25, v200
  v_fma_f32 v126, v126, s25, v200
  v_fma_f32 v127, v127, s25, v200
  v_fma_f32 v128, v128, s25, v200
  v_fma_f32 v129, v129, s25, v200
  v_fma_f32 v130, v130, s25, v200
  v_fma_f32 v131, v131, s25, v200
  v_fma_f32 v132, v132, s25, v200
  v_fma_f32 v133, v133, s25, v200
  v_fma_f32 v134, v134, s25, v200
  v_fma_f32 v135, v135, s25, v200
  v_fma_f32 v136, v136, s25, v200
  v_fma_f32 v137, v137, s25, v200
  v_fma_f32 v138, v138, s25, v200
  v_fma_f32 v139, v139, s25, v200
  v_fma_f32 v140, v140, s25, v200
  v_fma_f32 v141, v141, s25, v200
  v_fma_f32 v142, v142, s25, v200
  v_fma_f32 v143, v143, s25, v200
  v_exp_f32 v76, v76
  v_exp_f32 v77, v77
  v_exp_f32 v78, v78
  v_exp_f32 v79, v79
  v_exp_f32 v80, v80
  v_exp_f32 v81, v81
  v_exp_f32 v82, v82
  v_exp_f32 v83, v83
  v_exp_f32 v84, v84
  v_exp_f32 v85, v85
  v_exp_f32 v86, v86
  v_exp_f32 v87, v87
  v_exp_f32 v88, v88
  v_exp_f32 v89, v89
  v_exp_f32 v90, v90
  v_exp_f32 v91, v91
  v_exp_f32 v92, v92
  v_exp_f32 v93, v93
  v_exp_f32 v94, v94
  v_exp_f32 v95, v95
  v_exp_f32 v96, v96
  v_exp_f32 v97, v97
  v_exp_f32 v98, v98
  v_exp_f32 v99, v99
  v_exp_f32 v100, v100
  v_exp_f32 v101, v101
  v_exp_f32 v102, v102
  v_exp_f32 v103, v103
  v_exp_f32 v104, v104
  v_exp_f32 v105, v105
  v_exp_f32 v106, v106
  v_exp_f32 v107, v107
  v_exp_f32 v108, v108
  v_exp_f32 v109, v109
  v_exp_f32 v110, v110
  v_exp_f32 v111, v111
  v_exp_f32 v112, v112
  v_exp_f32 v113, v113
  v_exp_f32 v114, v114
  v_exp_f32 v115, v115
  v_exp_f32 v116, v116
  v_exp_f32 v117, v117
  v_exp_f32 v118, v118
  v_exp_f32 v119, v119
  v_exp_f32 v120, v120
  v_exp_f32 v121, v121
  v_exp_f32 v122, v122
  v_exp_f32 v123, v123
  v_exp_f32 v124, v124
  v_exp_f32 v125, v125
  v_exp_f32 v126, v126
  v_exp_f32 v127, v127
  v_exp_f32 v128, v128
  v_exp_f32 v129, v129
  v_exp_f32 v130, v130
  v_exp_f32 v131, v131
  v_exp_f32 v132, v132
  v_exp_f32 v133, v133
  v_exp_f32 v134, v134
  v_exp_f32 v135, v135
  v_exp_f32 v136, v136
  v_exp_f32 v137, v137
  v_exp_f32 v138, v138
  v_exp_f32 v139, v139
  v_exp_f32 v140, v140
  v_exp_f32 v141, v141
  v_exp_f32 v142, v142
  v_exp_f32 v143, v143
  v_add_f32 v202, v76, v80
  v_add_f32 v203, v77, v81
  v_add_f32 v204, v78, v82
  v_add_f32 v205, v79, v83
  v_add_f32 v202, v202, v84
  v_add_f32 v203, v203, v85
  v_add_f32 v204, v204, v86
  v_add_f32 v205, v205, v87
  v_add_f32 v202, v202, v88
  v_add_f32 v203, v203, v89
  v_add_f32 v204, v204, v90
  v_add_f32 v205, v205, v91
  v_add_f32 v202, v202, v92
  v_add_f32 v203, v203, v93
  v_add_f32 v204, v204, v94
  v_add_f32 v205, v205, v95
  v_add_f32 v202, v202, v96
  v_add_f32 v203, v203, v97
  v_add_f32 v204, v204, v98
  v_add_f32 v205, v205, v99
  v_add_f32 v202, v202, v100
  v_add_f32 v203, v203, v101
  v_add_f32 v204, v204, v102
  v_add_f32 v205, v205, v103
  v_add_f32 v202, v202, v104
  v_add_f32 v203, v203, v105
  v_add_f32 v204, v204, v106
  v_add_f32 v205, v205, v107
  v_add_f32 v202, v202, v108
  v_add_f32 v203, v203, v109
  v_add_f32 v204, v204, v110
  v_add_f32 v205, v205, v111
  v_add_f32 v202, v202, v112
  v_add_f32 v203, v203, v113
  v_add_f32 v204, v204, v114
  v_add_f32 v205, v205, v115
  v_add_f32 v202, v202, v116
  v_add_f32 v203, v203, v117
  v_add_f32 v204, v204, v118
  v_add_f32 v205, v205, v119
  v_add_f32 v202, v202, v120
  v_add_f32 v203, v203, v121
  v_add_f32 v204, v204, v122
  v_add_f32 v205, v205, v123
  v_add_f32 v202, v202, v124
  v_add_f32 v203, v203, v125
  v_add_f32 v204, v204, v126
  v_add_f32 v205, v205, v127
  v_add_f32 v202, v202, v128
  v_add_f32 v203, v203, v129
  v_add_f32 v204, v204, v130
  v_add_f32 v205, v205, v131
  v_add_f32 v202, v202, v132
  v_add_f32 v203, v203, v133
  v_add_f32 v204, v204, v134
  v_add_f32 v205, v205, v135
  v_add_f32 v202, v202, v136
  v_add_f32 v203, v203, v137
  v_add_f32 v204, v204, v138
  v_add_f32 v205, v205, v139
  v_add_f32 v202, v202, v140
  v_add_f32 v203, v203, v141
  v_add_f32 v204, v204, v142
  v_add_f32 v205, v205, v143
  v_cvt_pk_bf16_f32 v146, v76, v77
  v_cvt_pk_bf16_f32 v147, v78, v79
  v_cvt_pk_bf16_f32 v148, v80, v81
  v_cvt_pk_bf16_f32 v149, v82, v83
  v_cvt_pk_bf16_f32 v150, v84, v85
  v_cvt_pk_bf16_f32 v151, v86, v87
  v_cvt_pk_bf16_f32 v152, v88, v89
  v_cvt_pk_bf16_f32 v153, v90, v91
  v_cvt_pk_bf16_f32 v154, v92, v93
  v_cvt_pk_bf16_f32 v155, v94, v95
  v_cvt_pk_bf16_f32 v156, v96, v97
  v_cvt_pk_bf16_f32 v157, v98, v99
  v_cvt_pk_bf16_f32 v158, v100, v101
  v_cvt_pk_bf16_f32 v159, v102, v103
  v_cvt_pk_bf16_f32 v160, v104, v105
  v_cvt_pk_bf16_f32 v161, v106, v107
  v_cvt_pk_bf16_f32 v162, v108, v109
  v_cvt_pk_bf16_f32 v163, v110, v111
  v_cvt_pk_bf16_f32 v164, v112, v113
  v_cvt_pk_bf16_f32 v165, v114, v115
  v_cvt_pk_bf16_f32 v166, v116, v117
  v_cvt_pk_bf16_f32 v167, v118, v119
  v_cvt_pk_bf16_f32 v168, v120, v121
  v_cvt_pk_bf16_f32 v169, v122, v123
  v_cvt_pk_bf16_f32 v170, v124, v125
  v_cvt_pk_bf16_f32 v171, v126, v127
  v_cvt_pk_bf16_f32 v172, v128, v129
  v_cvt_pk_bf16_f32 v173, v130, v131
  v_cvt_pk_bf16_f32 v174, v132, v133
  v_cvt_pk_bf16_f32 v175, v134, v135
  v_cvt_pk_bf16_f32 v176, v136, v137
  v_cvt_pk_bf16_f32 v177, v138, v139
  v_cvt_pk_bf16_f32 v178, v140, v141
  v_cvt_pk_bf16_f32 v179, v142, v143
  v_add_f32 v202, v202, v203
  v_add_f32 v204, v204, v205
  v_add_f32 v202, v202, v204
  v_mov_b32 v203, v202
  s_nop 1
  v_permlane16_swap_b32 v202, v203
  v_add_f32 v202, v202, v203
  v_mov_b32 v203, v202
  s_nop 1
  v_permlane32_swap_b32 v202, v203
  v_add_f32 v202, v202, v203
  v_rcp_f32 v202, v202
  v_mfma_f32_16x16x32_bf16 v[180:183], v[40:43], v[144:147], 0
  v_mfma_f32_16x16x32_bf16 v[180:183], v[44:47], v[148:151], v[180:183]
  v_mfma_f32_16x16x32_bf16 v[180:183], v[48:51], v[152:155], v[180:183]
  v_mfma_f32_16x16x32_bf16 v[180:183], v[52:55], v[156:159], v[180:183]
  v_mfma_f32_16x16x32_bf16 v[180:183], v[56:59], v[160:163], v[180:183]
  v_mfma_f32_16x16x32_bf16 v[180:183], v[60:63], v[164:167], v[180:183]
  v_mfma_f32_16x16x32_bf16 v[180:183], v[64:67], v[168:171], v[180:183]
  v_mfma_f32_16x16x32_bf16 v[180:183], v[68:71], v[172:175], v[180:183]
  v_mfma_f32_16x16x32_bf16 v[180:183], v[72:75], v[176:179], v[180:183]
  s_nop 7
  v_mul_f32 v208, v202, v180
  v_mul_f32 v209, v202, v181
  v_mul_f32 v210, v202, v182
  v_mul_f32 v211, v202, v183
  v_cvt_pk_bf16_f32 v212, v208, v209
  v_cvt_pk_bf16_f32 v213, v210, v211
  buffer_store_dwordx2 v[212:213], v198, s[8:11], s23 offen
L_k2_end:
  s_endpgm
.globl k3_kernel
.p2align 8
.type k3_kernel,@function
k3_kernel:
  s_cmp_ge_u32 s2, 256
  s_cbranch_scc1 L_k3_end
  s_load_dwordx2 s[40:41], s[0:1], 0
  s_load_dwordx2 s[42:43], s[0:1], 16
  s_load_dwordx4 s[44:47], s[0:1], 48
  s_load_dwordx2 s[48:49], s[0:1], 72
  s_and_b32 s5, s2, 7
  s_lshr_b32 s4, s2, 3
  s_and_b32 s30, s4, 3
  s_lshl_b32 s30, s30, 3
  s_add_u32 s5, s5, s30
  s_lshr_b32 s4, s4, 2
  v_and_b32 v160, 63, v0
  v_lshrrev_b32 v184, 6, v0
  s_nop 0
  v_readfirstlane_b32 s3, v184
  v_and_b32 v161, 31, v160
  v_lshrrev_b32 v162, 5, v160
  s_waitcnt lgkmcnt(0)
  s_mov_b32 s8, s40
  s_and_b32 s9, s41, 0xffff
  s_mov_b32 s10, 0x200000
  s_mov_b32 s11, 0x20000
  s_mov_b32 s12, s42
  s_and_b32 s13, s43, 0xffff
  s_mov_b32 s14, 0x80000
  s_mov_b32 s15, 0x20000
  s_mov_b32 s16, s44
  s_and_b32 s17, s45, 0xffff
  s_mov_b32 s18, 0x1c0000
  s_mov_b32 s19, 0x20000
  s_mov_b32 s24, s46
  s_and_b32 s25, s47, 0xffff
  s_mov_b32 s26, 0x200000
  s_mov_b32 s27, 0x20000
  s_mov_b32 s20, s48
  s_and_b32 s21, s49, 0xffff
  s_mov_b32 s22, 0x1000000
  s_mov_b32 s23, 0x20000
  s_lshr_b32 s6, s3, 1
  s_and_b32 s7, s3, 1
  s_lshl_b32 s50, s5, 6
  s_lshl_b32 s53, s4, 7
  s_lshl_b32 s51, s3, 4
  s_add_u32 s51, s51, s50
  v_lshrrev_b32 v184, 3, v160
  v_add_u32 v184, s51, v184
  v_and_b32 v185, 7, v160
  v_lshrrev_b32 v186, 4, v160
  s_movk_i32 s52, 3584
  v_add_u32 v187, 0, v184
  v_add_u32 v188, 0, v186
  v_xor_b32 v188, v185, v188
  v_lshlrev_b32 v188, 4, v188
  v_lshlrev_b32 v168, 10, v187
  v_add_u32 v168, v168, v188
  v_mul_lo_u32 v170, v187, s52
  v_add_u32 v170, v170, v188
  v_add_u32 v187, 8, v184
  v_add_u32 v188, 4, v186
  v_xor_b32 v188, v185, v188
  v_lshlrev_b32 v188, 4, v188
  v_lshlrev_b32 v169, 10, v187
  v_add_u32 v169, v169, v188
  v_mul_lo_u32 v171, v187, s52
  v_add_u32 v171, v171, v188
  v_lshrrev_b32 v184, 2, v160
  s_lshl_b32 s54, s3, 4
  v_add_u32 v184, s54, v184
  v_lshlrev_b32 v164, 10, v184
  v_and_b32 v185, 3, v160
  v_lshlrev_b32 v185, 4, v185
  v_add_u32 v164, v164, v185
  v_add_u32 v164, s53, v164
  v_lshlrev_b32 v184, 7, v161
  v_lshrrev_b32 v185, 1, v161
  v_and_b32 v185, 7, v185
  v_lshlrev_b32 v186, 2, v162
  v_add_u32 v187, s3, v186
  v_xor_b32 v187, v187, v185
  v_lshlrev_b32 v187, 4, v187
  v_add_u32 v166, v184, v187
  v_add_u32 v167, 4096, v166
  v_lshrrev_b32 v186, 2, v160
  v_and_b32 v186, 3, v186
  v_lshlrev_b32 v187, 5, v162
  v_add_u32 v186, v186, v187
  v_lshlrev_b32 v186, 6, v186
  v_lshrrev_b32 v187, 4, v160
  v_and_b32 v187, 1, v187
  v_lshlrev_b32 v187, 5, v187
  v_and_b32 v188, 3, v160
  v_lshlrev_b32 v188, 3, v188
  v_add_u32 v163, v186, v187
  v_add_u32 v163, v163, v188
  s_lshl_b32 s54, s3, 9
  s_add_u32 s54, s54, 8192
  v_add_u32 v163, s54, v163
  s_lshl_b32 s54, s6, 5
  s_add_u32 s54, s54, s50
  v_add_u32 v184, s54, v161
  s_lshl_b32 s54, s7, 6
  s_add_u32 s54, s54, s53
  v_lshlrev_b32 v165, 10, v184
  v_add_u32 v165, s54, v165
  v_lshlrev_b32 v185, 3, v162
  v_add_u32 v189, v165, v185
  buffer_load_dwordx2 v[172:173], v189, s[8:11], 0 offen offset:0
  buffer_load_dwordx2 v[174:175], v189, s[8:11], 0 offen offset:16
  buffer_load_dwordx2 v[176:177], v189, s[8:11], 0 offen offset:32
  buffer_load_dwordx2 v[178:179], v189, s[8:11], 0 offen offset:48
  v_lshlrev_b32 v185, 4, v162
  v_add_u32 v165, v165, v185
  s_lshl_b32 s56, s3, 11
  s_lshl_b32 s59, s3, 10
  v_mov_b32 v0, 0
  v_mov_b32 v1, 0
  v_mov_b32 v2, 0
  v_mov_b32 v3, 0
  v_mov_b32 v4, 0
  v_mov_b32 v5, 0
  v_mov_b32 v6, 0
  v_mov_b32 v7, 0
  v_mov_b32 v8, 0
  v_mov_b32 v9, 0
  v_mov_b32 v10, 0
  v_mov_b32 v11, 0
  v_mov_b32 v12, 0
  v_mov_b32 v13, 0
  v_mov_b32 v14, 0
  v_mov_b32 v15, 0
  v_mov_b32 v16, 0
  v_mov_b32 v17, 0
  v_mov_b32 v18, 0
  v_mov_b32 v19, 0
  v_mov_b32 v20, 0
  v_mov_b32 v21, 0
  v_mov_b32 v22, 0
  v_mov_b32 v23, 0
  v_mov_b32 v24, 0
  v_mov_b32 v25, 0
  v_mov_b32 v26, 0
  v_mov_b32 v27, 0
  v_mov_b32 v28, 0
  v_mov_b32 v29, 0
  v_mov_b32 v30, 0
  v_mov_b32 v31, 0
  v_mov_b32 v32, 0
  v_mov_b32 v33, 0
  v_mov_b32 v34, 0
  v_mov_b32 v35, 0
  v_mov_b32 v36, 0
  v_mov_b32 v37, 0
  v_mov_b32 v38, 0
  v_mov_b32 v39, 0
  v_mov_b32 v40, 0
  v_mov_b32 v41, 0
  v_mov_b32 v42, 0
  v_mov_b32 v43, 0
  v_mov_b32 v44, 0
  v_mov_b32 v45, 0
  v_mov_b32 v46, 0
  v_mov_b32 v47, 0
  v_mov_b32 v48, 0
  v_mov_b32 v49, 0
  v_mov_b32 v50, 0
  v_mov_b32 v51, 0
  v_mov_b32 v52, 0
  v_mov_b32 v53, 0
  v_mov_b32 v54, 0
  v_mov_b32 v55, 0
  v_mov_b32 v56, 0
  v_mov_b32 v57, 0
  v_mov_b32 v58, 0
  v_mov_b32 v59, 0
  v_mov_b32 v60, 0
  v_mov_b32 v61, 0
  v_mov_b32 v62, 0
  v_mov_b32 v63, 0
  v_mov_b32 v64, 0
  v_mov_b32 v65, 0
  v_mov_b32 v66, 0
  v_mov_b32 v67, 0
  v_mov_b32 v68, 0
  v_mov_b32 v69, 0
  v_mov_b32 v70, 0
  v_mov_b32 v71, 0
  v_mov_b32 v72, 0
  v_mov_b32 v73, 0
  v_mov_b32 v74, 0
  v_mov_b32 v75, 0
  v_mov_b32 v76, 0
  v_mov_b32 v77, 0
  v_mov_b32 v78, 0
  v_mov_b32 v79, 0
  v_mov_b32 v80, 0
  v_mov_b32 v81, 0
  v_mov_b32 v82, 0
  v_mov_b32 v83, 0
  v_mov_b32 v84, 0
  v_mov_b32 v85, 0
  v_mov_b32 v86, 0
  v_mov_b32 v87, 0
  v_mov_b32 v88, 0
  v_mov_b32 v89, 0
  v_mov_b32 v90, 0
  v_mov_b32 v91, 0
  v_mov_b32 v92, 0
  v_mov_b32 v93, 0
  v_mov_b32 v94, 0
  v_mov_b32 v95, 0
  v_mov_b32 v96, 0
  v_mov_b32 v97, 0
  v_mov_b32 v98, 0
  v_mov_b32 v99, 0
  v_mov_b32 v100, 0
  v_mov_b32 v101, 0
  v_mov_b32 v102, 0
  v_mov_b32 v103, 0
  v_mov_b32 v104, 0
  v_mov_b32 v105, 0
  v_mov_b32 v106, 0
  v_mov_b32 v107, 0
  v_mov_b32 v108, 0
  v_mov_b32 v109, 0
  v_mov_b32 v110, 0
  v_mov_b32 v111, 0
  v_mov_b32 v112, 0
  v_mov_b32 v113, 0
  v_mov_b32 v114, 0
  v_mov_b32 v115, 0
  v_mov_b32 v116, 0
  v_mov_b32 v117, 0
  v_mov_b32 v118, 0
  v_mov_b32 v119, 0
  v_mov_b32 v120, 0
  v_mov_b32 v121, 0
  v_mov_b32 v122, 0
  v_mov_b32 v123, 0
  v_mov_b32 v124, 0
  v_mov_b32 v125, 0
  v_mov_b32 v126, 0
  v_mov_b32 v127, 0
  s_mov_b32 s63, 0
  s_mov_b32 s64, 0
  s_mov_b32 s58, 14680064
  s_mov_b32 s57, 0
  s_add_u32 s55, s56, s63
  s_add_u32 s55, s55, 0
  s_mov_b32 m0, s55
  s_nop 0
  buffer_load_dwordx4 v168, s[20:23], s58 offen lds
  s_add_u32 s55, s56, s63
  s_add_u32 s55, s55, 1024
  s_mov_b32 m0, s55
  s_nop 0
  buffer_load_dwordx4 v169, s[20:23], s58 offen lds
  s_add_u32 s55, s59, s63
  s_add_u32 s55, s55, 8192
  s_mov_b32 m0, s55
  s_nop 0
  buffer_load_dwordx4 v164, s[12:15], s57 offen lds
  s_add_u32 s55, s59, s63
  s_add_u32 s55, s55, 12288
  s_mov_b32 m0, s55
  s_add_u32 s66, s57, 64
  buffer_load_dwordx4 v164, s[12:15], s66 offen lds
  s_add_u32 s58, s58, 128
  s_add_u32 s57, s57, 65536
  s_add_u32 s63, s63, 16384
  s_cmp_eq_u32 s63, 147456
  s_cselect_b32 s63, 0, s63
  s_add_u32 s55, s56, s63
  s_add_u32 s55, s55, 0
  s_mov_b32 m0, s55
  s_nop 0
  buffer_load_dwordx4 v168, s[20:23], s58 offen lds
  s_add_u32 s55, s56, s63
  s_add_u32 s55, s55, 1024
  s_mov_b32 m0, s55
  s_nop 0
  buffer_load_dwordx4 v169, s[20:23], s58 offen lds
  s_add_u32 s55, s59, s63
  s_add_u32 s55, s55, 8192
  s_mov_b32 m0, s55
  s_nop 0
  buffer_load_dwordx4 v164, s[12:15], s57 offen lds
  s_add_u32 s55, s59, s63
  s_add_u32 s55, s55, 12288
  s_mov_b32 m0, s55
  s_add_u32 s66, s57, 64
  buffer_load_dwordx4 v164, s[12:15], s66 offen lds
  s_add_u32 s58, s58, 128
  s_add_u32 s57, s57, 65536
  s_add_u32 s63, s63, 16384
  s_cmp_eq_u32 s63, 147456
  s_cselect_b32 s63, 0, s63
  s_add_u32 s55, s56, s63
  s_add_u32 s55, s55, 0
  s_mov_b32 m0, s55
  s_nop 0
  buffer_load_dwordx4 v168, s[20:23], s58 offen lds
  s_add_u32 s55, s56, s63
  s_add_u32 s55, s55, 1024
  s_mov_b32 m0, s55
  s_nop 0
  buffer_load_dwordx4 v169, s[20:23], s58 offen lds
  s_add_u32 s55, s59, s63
  s_add_u32 s55, s55, 8192
  s_mov_b32 m0, s55
  s_nop 0
  buffer_load_dwordx4 v164, s[12:15], s57 offen lds
  s_add_u32 s55, s59, s63
  s_add_u32 s55, s55, 12288
  s_mov_b32 m0, s55
  s_add_u32 s66, s57, 64
  buffer_load_dwordx4 v164, s[12:15], s66 offen lds
  s_add_u32 s58, s58, 128
  s_add_u32 s57, s57, 65536
  s_add_u32 s63, s63, 16384
  s_cmp_eq_u32 s63, 147456
  s_cselect_b32 s63, 0, s63
  s_add_u32 s55, s56, s63
  s_add_u32 s55, s55, 0
  s_mov_b32 m0, s55
  s_nop 0
  buffer_load_dwordx4 v168, s[20:23], s58 offen lds
  s_add_u32 s55, s56, s63
  s_add_u32 s55, s55, 1024
  s_mov_b32 m0, s55
  s_nop 0
  buffer_load_dwordx4 v169, s[20:23], s58 offen lds
  s_add_u32 s55, s59, s63
  s_add_u32 s55, s55, 8192
  s_mov_b32 m0, s55
  s_nop 0
  buffer_load_dwordx4 v164, s[12:15], s57 offen lds
  s_add_u32 s55, s59, s63
  s_add_u32 s55, s55, 12288
  s_mov_b32 m0, s55
  s_add_u32 s66, s57, 64
  buffer_load_dwordx4 v164, s[12:15], s66 offen lds
  s_add_u32 s58, s58, 128
  s_add_u32 s57, s57, 65536
  s_add_u32 s63, s63, 16384
  s_cmp_eq_u32 s63, 147456
  s_cselect_b32 s63, 0, s63
  s_add_u32 s55, s56, s63
  s_add_u32 s55, s55, 0
  s_mov_b32 m0, s55
  s_nop 0
  buffer_load_dwordx4 v168, s[20:23], s58 offen lds
  s_add_u32 s55, s56, s63
  s_add_u32 s55, s55, 1024
  s_mov_b32 m0, s55
  s_nop 0
  buffer_load_dwordx4 v169, s[20:23], s58 offen lds
  s_add_u32 s55, s59, s63
  s_add_u32 s55, s55, 8192
  s_mov_b32 m0, s55
  s_nop 0
  buffer_load_dwordx4 v164, s[12:15], s57 offen lds
  s_add_u32 s55, s59, s63
  s_add_u32 s55, s55, 12288
  s_mov_b32 m0, s55
  s_add_u32 s66, s57, 64
  buffer_load_dwordx4 v164, s[12:15], s66 offen lds
  s_add_u32 s58, s58, 128
  s_add_u32 s57, s57, 65536
  s_add_u32 s63, s63, 16384
  s_cmp_eq_u32 s63, 147456
  s_cselect_b32 s63, 0, s63
  s_add_u32 s55, s56, s63
  s_add_u32 s55, s55, 0
  s_mov_b32 m0, s55
  s_nop 0
  buffer_load_dwordx4 v168, s[20:23], s58 offen lds
  s_add_u32 s55, s56, s63
  s_add_u32 s55, s55, 1024
  s_mov_b32 m0, s55
  s_nop 0
  buffer_load_dwordx4 v169, s[20:23], s58 offen lds
  s_add_u32 s55, s59, s63
  s_add_u32 s55, s55, 8192
  s_mov_b32 m0, s55
  s_nop 0
  buffer_load_dwordx4 v164, s[12:15], s57 offen lds
  s_add_u32 s55, s59, s63
  s_add_u32 s55, s55, 12288
  s_mov_b32 m0, s55
  s_add_u32 s66, s57, 64
  buffer_load_dwordx4 v164, s[12:15], s66 offen lds
  s_add_u32 s58, s58, 128
  s_add_u32 s57, s57, 65536
  s_add_u32 s63, s63, 16384
  s_cmp_eq_u32 s63, 147456
  s_cselect_b32 s63, 0, s63
  s_add_u32 s55, s56, s63
  s_add_u32 s55, s55, 0
  s_mov_b32 m0, s55
  s_nop 0
  buffer_load_dwordx4 v168, s[20:23], s58 offen lds
  s_add_u32 s55, s56, s63
  s_add_u32 s55, s55, 1024
  s_mov_b32 m0, s55
  s_nop 0
  buffer_load_dwordx4 v169, s[20:23], s58 offen lds
  s_add_u32 s55, s59, s63
  s_add_u32 s55, s55, 8192
  s_mov_b32 m0, s55
  s_nop 0
  buffer_load_dwordx4 v164, s[12:15], s57 offen lds
  s_add_u32 s55, s59, s63
  s_add_u32 s55, s55, 12288
  s_mov_b32 m0, s55
  s_add_u32 s66, s57, 64
  buffer_load_dwordx4 v164, s[12:15], s66 offen lds
  s_add_u32 s58, s58, 128
  s_add_u32 s57, s57, 65536
  s_add_u32 s63, s63, 16384
  s_cmp_eq_u32 s63, 147456
  s_cselect_b32 s63, 0, s63
  s_add_u32 s55, s56, s63
  s_add_u32 s55, s55, 0
  s_mov_b32 m0, s55
  s_nop 0
  buffer_load_dwordx4 v168, s[20:23], s58 offen lds
  s_add_u32 s55, s56, s63
  s_add_u32 s55, s55, 1024
  s_mov_b32 m0, s55
  s_nop 0
  buffer_load_dwordx4 v169, s[20:23], s58 offen lds
  s_add_u32 s55, s59, s63
  s_add_u32 s55, s55, 8192
  s_mov_b32 m0, s55
  s_nop 0
  buffer_load_dwordx4 v164, s[12:15], s57 offen lds
  s_add_u32 s55, s59, s63
  s_add_u32 s55, s55, 12288
  s_mov_b32 m0, s55
  s_add_u32 s66, s57, 64
  buffer_load_dwordx4 v164, s[12:15], s66 offen lds
  s_add_u32 s58, s58, 128
  s_add_u32 s57, s57, 65536
  s_add_u32 s63, s63, 16384
  s_cmp_eq_u32 s63, 147456
  s_cselect_b32 s63, 0, s63
  s_mov_b32 s58, 6291456
  s_mov_b32 s57, 0
  s_add_u32 s65, s64, 16384
  s_cmp_eq_u32 s65, 147456
  s_cselect_b32 s65, 0, s65
  v_add_u32 v200, s64, v166
  v_add_u32 v204, s65, v166
  v_add_u32 v201, s64, v167
  v_add_u32 v205, s65, v167
  v_add_u32 v202, s64, v163
  v_add_u32 v206, s65, v163
  s_waitcnt vmcnt(28)
  s_barrier
  ds_read_b128 v[144:147], v200
  ds_read_b128 v[148:151], v201
  ds_read_b64_tr_b16 v[128:129], v202 offset:0
  ds_read_b64_tr_b16 v[130:131], v202 offset:256
  ds_read_b64_tr_b16 v[132:133], v202 offset:4096
  ds_read_b64_tr_b16 v[134:135], v202 offset:4352
  s_mov_b32 s67, 4
L_k3_p1:
  s_nop 7
  s_nop 4
  s_waitcnt vmcnt(24)
  s_barrier
  s_add_u32 s55, s56, s63
  s_add_u32 s55, s55, 0
  s_mov_b32 m0, s55
  s_nop 0
  buffer_load_dwordx4 v170, s[20:23], s58 offen lds
  s_add_u32 s55, s56, s63
  s_add_u32 s55, s55, 1024
  s_mov_b32 m0, s55
  s_nop 0
  buffer_load_dwordx4 v171, s[20:23], s58 offen lds
  s_add_u32 s55, s59, s63
  s_add_u32 s55, s55, 8192
  s_mov_b32 m0, s55
  s_nop 0
  buffer_load_dwordx4 v164, s[16:19], s57 offen lds
  s_add_u32 s55, s59, s63
  s_add_u32 s55, s55, 12288
  s_mov_b32 m0, s55
  s_add_u32 s66, s57, 64
  buffer_load_dwordx4 v164, s[16:19], s66 offen lds
  s_add_u32 s58, s58, 128
  s_add_u32 s57, s57, 65536
  s_add_u32 s63, s63, 16384
  s_cmp_eq_u32 s63, 147456
  s_cselect_b32 s63, 0, s63
  ds_read_b128 v[152:155], v204
  ds_read_b128 v[156:159], v205
  ds_read_b64_tr_b16 v[136:137], v206 offset:0
  ds_read_b64_tr_b16 v[138:139], v206 offset:256
  ds_read_b64_tr_b16 v[140:141], v206 offset:4096
  ds_read_b64_tr_b16 v[142:143], v206 offset:4352
  s_waitcnt lgkmcnt(6)
  v_mfma_f32_32x32x16_bf16 v[0:15], v[128:131], v[144:147], v[0:15]
  v_mfma_f32_32x32x16_bf16 v[16:31], v[132:135], v[144:147], v[16:31]
  v_mfma_f32_32x32x16_bf16 v[32:47], v[128:131], v[148:151], v[32:47]
  v_mfma_f32_32x32x16_bf16 v[48:63], v[132:135], v[148:151], v[48:63]
  s_mov_b32 s64, s65
  s_add_u32 s65, s64, 16384
  s_cmp_eq_u32 s65, 147456
  s_cselect_b32 s65, 0, s65
  v_add_u32 v200, s64, v166
  v_add_u32 v204, s65, v166
  v_add_u32 v201, s64, v167
  v_add_u32 v205, s65, v167
  v_add_u32 v202, s64, v163
  v_add_u32 v206, s65, v163
  s_waitcnt vmcnt(24)
  s_barrier
  s_add_u32 s55, s56, s63
  s_add_u32 s55, s55, 0
  s_mov_b32 m0, s55
  s_nop 0
  buffer_load_dwordx4 v170, s[20:23], s58 offen lds
  s_add_u32 s55, s56, s63
  s_add_u32 s55, s55, 1024
  s_mov_b32 m0, s55
  s_nop 0
  buffer_load_dwordx4 v171, s[20:23], s58 offen lds
  s_add_u32 s55, s59, s63
  s_add_u32 s55, s55, 8192
  s_mov_b32 m0, s55
  s_nop 0
  buffer_load_dwordx4 v164, s[16:19], s57 offen lds
  s_add_u32 s55, s59, s63
  s_add_u32 s55, s55, 12288
  s_mov_b32 m0, s55
  s_add_u32 s66, s57, 64
  buffer_load_dwordx4 v164, s[16:19], s66 offen lds
  s_add_u32 s58, s58, 128
  s_add_u32 s57, s57, 65536
  s_add_u32 s63, s63, 16384
  s_cmp_eq_u32 s63, 147456
  s_cselect_b32 s63, 0, s63
  ds_read_b128 v[144:147], v204
  ds_read_b128 v[148:151], v205
  ds_read_b64_tr_b16 v[128:129], v206 offset:0
  ds_read_b64_tr_b16 v[130:131], v206 offset:256
  ds_read_b64_tr_b16 v[132:133], v206 offset:4096
  ds_read_b64_tr_b16 v[134:135], v206 offset:4352
  s_waitcnt lgkmcnt(6)
  v_mfma_f32_32x32x16_bf16 v[0:15], v[136:139], v[152:155], v[0:15]
  v_mfma_f32_32x32x16_bf16 v[16:31], v[140:143], v[152:155], v[16:31]
  v_mfma_f32_32x32x16_bf16 v[32:47], v[136:139], v[156:159], v[32:47]
  v_mfma_f32_32x32x16_bf16 v[48:63], v[140:143], v[156:159], v[48:63]
  s_mov_b32 s64, s65
  s_add_u32 s65, s64, 16384
  s_cmp_eq_u32 s65, 147456
  s_cselect_b32 s65, 0, s65
  v_add_u32 v200, s64, v166
  v_add_u32 v204, s65, v166
  v_add_u32 v201, s64, v167
  v_add_u32 v205, s65, v167
  v_add_u32 v202, s64, v163
  v_add_u32 v206, s65, v163
  s_sub_u32 s67, s67, 1
  s_cmp_lg_u32 s67, 0
  s_cbranch_scc1 L_k3_p1
  s_mov_b32 s67, 14
L_k3_p2:
  s_nop 7
  s_nop 4
  s_waitcnt vmcnt(24)
  s_barrier
  s_add_u32 s55, s56, s63
  s_add_u32 s55, s55, 0
  s_mov_b32 m0, s55
  s_nop 0
  buffer_load_dwordx4 v170, s[20:23], s58 offen lds
  s_add_u32 s55, s56, s63
  s_add_u32 s55, s55, 1024
  s_mov_b32 m0, s55
  s_nop 0
  buffer_load_dwordx4 v171, s[20:23], s58 offen lds
  s_add_u32 s55, s59, s63
  s_add_u32 s55, s55, 8192
  s_mov_b32 m0, s55
  s_nop 0
  buffer_load_dwordx4 v164, s[16:19], s57 offen lds
  s_add_u32 s55, s59, s63
  s_add_u32 s55, s55, 12288
  s_mov_b32 m0, s55
  s_add_u32 s66, s57, 64
  buffer_load_dwordx4 v164, s[16:19], s66 offen lds
  s_add_u32 s58, s58, 128
  s_add_u32 s57, s57, 65536
  s_add_u32 s63, s63, 16384
  s_cmp_eq_u32 s63, 147456
  s_cselect_b32 s63, 0, s63
  ds_read_b128 v[152:155], v204
  ds_read_b128 v[156:159], v205
  ds_read_b64_tr_b16 v[136:137], v206 offset:0
  ds_read_b64_tr_b16 v[138:139], v206 offset:256
  ds_read_b64_tr_b16 v[140:141], v206 offset:4096
  ds_read_b64_tr_b16 v[142:143], v206 offset:4352
  s_waitcnt lgkmcnt(6)
  v_mfma_f32_32x32x16_bf16 v[64:79], v[128:131], v[144:147], v[64:79]
  v_mfma_f32_32x32x16_bf16 v[80:95], v[132:135], v[144:147], v[80:95]
  v_mfma_f32_32x32x16_bf16 v[96:111], v[128:131], v[148:151], v[96:111]
  v_mfma_f32_32x32x16_bf16 v[112:127], v[132:135], v[148:151], v[112:127]
  s_mov_b32 s64, s65
  s_add_u32 s65, s64, 16384
  s_cmp_eq_u32 s65, 147456
  s_cselect_b32 s65, 0, s65
  v_add_u32 v200, s64, v166
  v_add_u32 v204, s65, v166
  v_add_u32 v201, s64, v167
  v_add_u32 v205, s65, v167
  v_add_u32 v202, s64, v163
  v_add_u32 v206, s65, v163
  s_waitcnt vmcnt(24)
  s_barrier
  s_add_u32 s55, s56, s63
  s_add_u32 s55, s55, 0
  s_mov_b32 m0, s55
  s_nop 0
  buffer_load_dwordx4 v170, s[20:23], s58 offen lds
  s_add_u32 s55, s56, s63
  s_add_u32 s55, s55, 1024
  s_mov_b32 m0, s55
  s_nop 0
  buffer_load_dwordx4 v171, s[20:23], s58 offen lds
  s_add_u32 s55, s59, s63
  s_add_u32 s55, s55, 8192
  s_mov_b32 m0, s55
  s_nop 0
  buffer_load_dwordx4 v164, s[16:19], s57 offen lds
  s_add_u32 s55, s59, s63
  s_add_u32 s55, s55, 12288
  s_mov_b32 m0, s55
  s_add_u32 s66, s57, 64
  buffer_load_dwordx4 v164, s[16:19], s66 offen lds
  s_add_u32 s58, s58, 128
  s_add_u32 s57, s57, 65536
  s_add_u32 s63, s63, 16384
  s_cmp_eq_u32 s63, 147456
  s_cselect_b32 s63, 0, s63
  ds_read_b128 v[144:147], v204
  ds_read_b128 v[148:151], v205
  ds_read_b64_tr_b16 v[128:129], v206 offset:0
  ds_read_b64_tr_b16 v[130:131], v206 offset:256
  ds_read_b64_tr_b16 v[132:133], v206 offset:4096
  ds_read_b64_tr_b16 v[134:135], v206 offset:4352
  s_waitcnt lgkmcnt(6)
  v_mfma_f32_32x32x16_bf16 v[64:79], v[136:139], v[152:155], v[64:79]
  v_mfma_f32_32x32x16_bf16 v[80:95], v[140:143], v[152:155], v[80:95]
  v_mfma_f32_32x32x16_bf16 v[96:111], v[136:139], v[156:159], v[96:111]
  v_mfma_f32_32x32x16_bf16 v[112:127], v[140:143], v[156:159], v[112:127]
  s_mov_b32 s64, s65
  s_add_u32 s65, s64, 16384
  s_cmp_eq_u32 s65, 147456
  s_cselect_b32 s65, 0, s65
  v_add_u32 v200, s64, v166
  v_add_u32 v204, s65, v166
  v_add_u32 v201, s64, v167
  v_add_u32 v205, s65, v167
  v_add_u32 v202, s64, v163
  v_add_u32 v206, s65, v163
  s_sub_u32 s67, s67, 1
  s_cmp_lg_u32 s67, 0
  s_cbranch_scc1 L_k3_p2
  s_waitcnt vmcnt(0) lgkmcnt(0)
  s_barrier
  v_lshlrev_b32 v184, 4, v160
  s_lshl_b32 s54, s3, 15
  v_add_u32 v185, s54, v184
  ds_write_b128 v185, v[0:3] offset:0
  ds_write_b128 v185, v[4:7] offset:1024
  ds_write_b128 v185, v[8:11] offset:2048
  ds_write_b128 v185, v[12:15] offset:3072
  ds_write_b128 v185, v[16:19] offset:4096
  ds_write_b128 v185, v[20:23] offset:5120
  ds_write_b128 v185, v[24:27] offset:6144
  ds_write_b128 v185, v[28:31] offset:7168
  ds_write_b128 v185, v[32:35] offset:8192
  ds_write_b128 v185, v[36:39] offset:9216
  ds_write_b128 v185, v[40:43] offset:10240
  ds_write_b128 v185, v[44:47] offset:11264
  ds_write_b128 v185, v[48:51] offset:12288
  ds_write_b128 v185, v[52:55] offset:13312
  ds_write_b128 v185, v[56:59] offset:14336
  ds_write_b128 v185, v[60:63] offset:15360
  ds_write_b128 v185, v[64:67] offset:16384
  ds_write_b128 v185, v[68:71] offset:17408
  ds_write_b128 v185, v[72:75] offset:18432
  ds_write_b128 v185, v[76:79] offset:19456
  ds_write_b128 v185, v[80:83] offset:20480
  ds_write_b128 v185, v[84:87] offset:21504
  ds_write_b128 v185, v[88:91] offset:22528
  ds_write_b128 v185, v[92:95] offset:23552
  ds_write_b128 v185, v[96:99] offset:24576
  ds_write_b128 v185, v[100:103] offset:25600
  ds_write_b128 v185, v[104:107] offset:26624
  ds_write_b128 v185, v[108:111] offset:27648
  ds_write_b128 v185, v[112:115] offset:28672
  ds_write_b128 v185, v[116:119] offset:29696
  ds_write_b128 v185, v[120:123] offset:30720
  ds_write_b128 v185, v[124:127] offset:31744
  s_waitcnt lgkmcnt(0)
  s_barrier
  s_lshl_b32 s54, s3, 12
  v_add_u32 v185, s54, v184
  v_add_u32 v186, 0x10000, v185
  ds_read_b128 v[32:35], v185 offset:0
  ds_read_b128 v[36:39], v185 offset:1024
  ds_read_b128 v[40:43], v185 offset:2048
  ds_read_b128 v[44:47], v185 offset:3072
  ds_read_b128 v[48:51], v185 offset:32768
  ds_read_b128 v[52:55], v185 offset:33792
  ds_read_b128 v[56:59], v185 offset:34816
  ds_read_b128 v[60:63], v185 offset:35840
  ds_read_b128 v[64:67], v186 offset:0
  ds_read_b128 v[68:71], v186 offset:1024
  ds_read_b128 v[72:75], v186 offset:2048
  ds_read_b128 v[76:79], v186 offset:3072
  ds_read_b128 v[80:83], v186 offset:32768
  ds_read_b128 v[84:87], v186 offset:33792
  ds_read_b128 v[88:91], v186 offset:34816
  ds_read_b128 v[92:95], v186 offset:35840
  s_waitcnt lgkmcnt(0)
  v_add_f32 v32, v32, v48
  v_add_f32 v64, v64, v80
  v_add_f32 v0, v32, v64
  v_add_f32 v33, v33, v49
  v_add_f32 v65, v65, v81
  v_add_f32 v1, v33, v65
  v_add_f32 v34, v34, v50
  v_add_f32 v66, v66, v82
  v_add_f32 v2, v34, v66
  v_add_f32 v35, v35, v51
  v_add_f32 v67, v67, v83
  v_add_f32 v3, v35, v67
  v_add_f32 v36, v36, v52
  v_add_f32 v68, v68, v84
  v_add_f32 v4, v36, v68
  v_add_f32 v37, v37, v53
  v_add_f32 v69, v69, v85
  v_add_f32 v5, v37, v69
  v_add_f32 v38, v38, v54
  v_add_f32 v70, v70, v86
  v_add_f32 v6, v38, v70
  v_add_f32 v39, v39, v55
  v_add_f32 v71, v71, v87
  v_add_f32 v7, v39, v71
  v_add_f32 v40, v40, v56
  v_add_f32 v72, v72, v88
  v_add_f32 v8, v40, v72
  v_add_f32 v41, v41, v57
  v_add_f32 v73, v73, v89
  v_add_f32 v9, v41, v73
  v_add_f32 v42, v42, v58
  v_add_f32 v74, v74, v90
  v_add_f32 v10, v42, v74
  v_add_f32 v43, v43, v59
  v_add_f32 v75, v75, v91
  v_add_f32 v11, v43, v75
  v_add_f32 v44, v44, v60
  v_add_f32 v76, v76, v92
  v_add_f32 v12, v44, v76
  v_add_f32 v45, v45, v61
  v_add_f32 v77, v77, v93
  v_add_f32 v13, v45, v77
  v_add_f32 v46, v46, v62
  v_add_f32 v78, v78, v94
  v_add_f32 v14, v46, v78
  v_add_f32 v47, v47, v63
  v_add_f32 v79, v79, v95
  v_add_f32 v15, v47, v79
  ds_read_b128 v[32:35], v185 offset:16384
  ds_read_b128 v[36:39], v185 offset:17408
  ds_read_b128 v[40:43], v185 offset:18432
  ds_read_b128 v[44:47], v185 offset:19456
  ds_read_b128 v[48:51], v185 offset:49152
  ds_read_b128 v[52:55], v185 offset:50176
  ds_read_b128 v[56:59], v185 offset:51200
  ds_read_b128 v[60:63], v185 offset:52224
  ds_read_b128 v[64:67], v186 offset:16384
  ds_read_b128 v[68:71], v186 offset:17408
  ds_read_b128 v[72:75], v186 offset:18432
  ds_read_b128 v[76:79], v186 offset:19456
  ds_read_b128 v[80:83], v186 offset:49152
  ds_read_b128 v[84:87], v186 offset:50176
  ds_read_b128 v[88:91], v186 offset:51200
  ds_read_b128 v[92:95], v186 offset:52224
  s_waitcnt lgkmcnt(0)
  v_add_f32 v32, v32, v48
  v_add_f32 v64, v64, v80
  v_add_f32 v16, v32, v64
  v_add_f32 v33, v33, v49
  v_add_f32 v65, v65, v81
  v_add_f32 v17, v33, v65
  v_add_f32 v34, v34, v50
  v_add_f32 v66, v66, v82
  v_add_f32 v18, v34, v66
  v_add_f32 v35, v35, v51
  v_add_f32 v67, v67, v83
  v_add_f32 v19, v35, v67
  v_add_f32 v36, v36, v52
  v_add_f32 v68, v68, v84
  v_add_f32 v20, v36, v68
  v_add_f32 v37, v37, v53
  v_add_f32 v69, v69, v85
  v_add_f32 v21, v37, v69
  v_add_f32 v38, v38, v54
  v_add_f32 v70, v70, v86
  v_add_f32 v22, v38, v70
  v_add_f32 v39, v39, v55
  v_add_f32 v71, v71, v87
  v_add_f32 v23, v39, v71
  v_add_f32 v40, v40, v56
  v_add_f32 v72, v72, v88
  v_add_f32 v24, v40, v72
  v_add_f32 v41, v41, v57
  v_add_f32 v73, v73, v89
  v_add_f32 v25, v41, v73
  v_add_f32 v42, v42, v58
  v_add_f32 v74, v74, v90
  v_add_f32 v26, v42, v74
  v_add_f32 v43, v43, v59
  v_add_f32 v75, v75, v91
  v_add_f32 v27, v43, v75
  v_add_f32 v44, v44, v60
  v_add_f32 v76, v76, v92
  v_add_f32 v28, v44, v76
  v_add_f32 v45, v45, v61
  v_add_f32 v77, v77, v93
  v_add_f32 v29, v45, v77
  v_add_f32 v46, v46, v62
  v_add_f32 v78, v78, v94
  v_add_f32 v30, v46, v78
  v_add_f32 v47, v47, v63
  v_add_f32 v79, v79, v95
  v_add_f32 v31, v47, v79
  s_mov_b32 s60, 0xbfb8aa3b
  v_mul_f32 v192, s60, v16
  v_exp_f32 v192, v192
  s_nop 0
  v_add_f32 v192, 1.0, v192
  v_rcp_f32 v192, v192
  s_nop 0
  v_mul_f32 v192, v192, v16
  v_mul_f32 v0, v0, v192
  v_mul_f32 v194, s60, v17
  v_exp_f32 v194, v194
  s_nop 0
  v_add_f32 v194, 1.0, v194
  v_rcp_f32 v194, v194
  s_nop 0
  v_mul_f32 v194, v194, v17
  v_mul_f32 v1, v1, v194
  v_mul_f32 v196, s60, v18
  v_exp_f32 v196, v196
  s_nop 0
  v_add_f32 v196, 1.0, v196
  v_rcp_f32 v196, v196
  s_nop 0
  v_mul_f32 v196, v196, v18
  v_mul_f32 v2, v2, v196
  v_mul_f32 v198, s60, v19
  v_exp_f32 v198, v198
  s_nop 0
  v_add_f32 v198, 1.0, v198
  v_rcp_f32 v198, v198
  s_nop 0
  v_mul_f32 v198, v198, v19
  v_mul_f32 v3, v3, v198
  v_mul_f32 v192, s60, v20
  v_exp_f32 v192, v192
  s_nop 0
  v_add_f32 v192, 1.0, v192
  v_rcp_f32 v192, v192
  s_nop 0
  v_mul_f32 v192, v192, v20
  v_mul_f32 v4, v4, v192
  v_mul_f32 v194, s60, v21
  v_exp_f32 v194, v194
  s_nop 0
  v_add_f32 v194, 1.0, v194
  v_rcp_f32 v194, v194
  s_nop 0
  v_mul_f32 v194, v194, v21
  v_mul_f32 v5, v5, v194
  v_mul_f32 v196, s60, v22
  v_exp_f32 v196, v196
  s_nop 0
  v_add_f32 v196, 1.0, v196
  v_rcp_f32 v196, v196
  s_nop 0
  v_mul_f32 v196, v196, v22
  v_mul_f32 v6, v6, v196
  v_mul_f32 v198, s60, v23
  v_exp_f32 v198, v198
  s_nop 0
  v_add_f32 v198, 1.0, v198
  v_rcp_f32 v198, v198
  s_nop 0
  v_mul_f32 v198, v198, v23
  v_mul_f32 v7, v7, v198
  v_mul_f32 v192, s60, v24
  v_exp_f32 v192, v192
  s_nop 0
  v_add_f32 v192, 1.0, v192
  v_rcp_f32 v192, v192
  s_nop 0
  v_mul_f32 v192, v192, v24
  v_mul_f32 v8, v8, v192
  v_mul_f32 v194, s60, v25
  v_exp_f32 v194, v194
  s_nop 0
  v_add_f32 v194, 1.0, v194
  v_rcp_f32 v194, v194
  s_nop 0
  v_mul_f32 v194, v194, v25
  v_mul_f32 v9, v9, v194
  v_mul_f32 v196, s60, v26
  v_exp_f32 v196, v196
  s_nop 0
  v_add_f32 v196, 1.0, v196
  v_rcp_f32 v196, v196
  s_nop 0
  v_mul_f32 v196, v196, v26
  v_mul_f32 v10, v10, v196
  v_mul_f32 v198, s60, v27
  v_exp_f32 v198, v198
  s_nop 0
  v_add_f32 v198, 1.0, v198
  v_rcp_f32 v198, v198
  s_nop 0
  v_mul_f32 v198, v198, v27
  v_mul_f32 v11, v11, v198
  v_mul_f32 v192, s60, v28
  v_exp_f32 v192, v192
  s_nop 0
  v_add_f32 v192, 1.0, v192
  v_rcp_f32 v192, v192
  s_nop 0
  v_mul_f32 v192, v192, v28
  v_mul_f32 v12, v12, v192
  v_mul_f32 v194, s60, v29
  v_exp_f32 v194, v194
  s_nop 0
  v_add_f32 v194, 1.0, v194
  v_rcp_f32 v194, v194
  s_nop 0
  v_mul_f32 v194, v194, v29
  v_mul_f32 v13, v13, v194
  v_mul_f32 v196, s60, v30
  v_exp_f32 v196, v196
  s_nop 0
  v_add_f32 v196, 1.0, v196
  v_rcp_f32 v196, v196
  s_nop 0
  v_mul_f32 v196, v196, v30
  v_mul_f32 v14, v14, v196
  v_mul_f32 v198, s60, v31
  v_exp_f32 v198, v198
  s_nop 0
  v_add_f32 v198, 1.0, v198
  v_rcp_f32 v198, v198
  s_nop 0
  v_mul_f32 v198, v198, v31
  v_mul_f32 v15, v15, v198
  v_lshlrev_b32 v200, 16, v172
  v_add_f32 v0, v0, v200
  v_and_b32 v200, 0xffff0000, v172
  v_add_f32 v1, v1, v200
  v_lshlrev_b32 v201, 16, v173
  v_add_f32 v2, v2, v201
  v_and_b32 v201, 0xffff0000, v173
  v_add_f32 v3, v3, v201
  v_lshlrev_b32 v200, 16, v174
  v_add_f32 v4, v4, v200
  v_and_b32 v200, 0xffff0000, v174
  v_add_f32 v5, v5, v200
  v_lshlrev_b32 v201, 16, v175
  v_add_f32 v6, v6, v201
  v_and_b32 v201, 0xffff0000, v175
  v_add_f32 v7, v7, v201
  v_lshlrev_b32 v200, 16, v176
  v_add_f32 v8, v8, v200
  v_and_b32 v200, 0xffff0000, v176
  v_add_f32 v9, v9, v200
  v_lshlrev_b32 v201, 16, v177
  v_add_f32 v10, v10, v201
  v_and_b32 v201, 0xffff0000, v177
  v_add_f32 v11, v11, v201
  v_lshlrev_b32 v200, 16, v178
  v_add_f32 v12, v12, v200
  v_and_b32 v200, 0xffff0000, v178
  v_add_f32 v13, v13, v200
  v_lshlrev_b32 v201, 16, v179
  v_add_f32 v14, v14, v201
  v_and_b32 v201, 0xffff0000, v179
  v_add_f32 v15, v15, v201
  v_cvt_pk_bf16_f32 v184, v0, v1
  v_cvt_pk_bf16_f32 v185, v2, v3
  v_cvt_pk_bf16_f32 v186, v4, v5
  v_cvt_pk_bf16_f32 v187, v6, v7
  v_cvt_pk_bf16_f32 v188, v8, v9
  v_cvt_pk_bf16_f32 v189, v10, v11
  v_cvt_pk_bf16_f32 v190, v12, v13
  v_cvt_pk_bf16_f32 v191, v14, v15
  v_permlane32_swap_b32 v184, v186
  v_permlane32_swap_b32 v185, v187
  v_permlane32_swap_b32 v188, v190
  v_permlane32_swap_b32 v189, v191
  buffer_store_dwordx4 v[184:187], v165, s[24:27], 0 offen
  buffer_store_dwordx4 v[188:191], v165, s[24:27], 0 offen offset:32
  s_waitcnt vmcnt(0)
L_k3_end:
  s_endpgm
.section .rodata,"a"
.p2align 6
.amdhsa_kernel k1_kernel
  .amdhsa_next_free_vgpr 256
  .amdhsa_next_free_sgpr 102
  .amdhsa_accum_offset 256
  .amdhsa_group_segment_fixed_size 0
  .amdhsa_kernarg_size 80
  .amdhsa_user_sgpr_count 2
  .amdhsa_user_sgpr_kernarg_segment_ptr 1
  .amdhsa_system_sgpr_workgroup_id_x 1
.end_amdhsa_kernel
.p2align 6
.amdhsa_kernel k2_kernel
  .amdhsa_next_free_vgpr 256
  .amdhsa_next_free_sgpr 102
  .amdhsa_accum_offset 256
  .amdhsa_group_segment_fixed_size 0
  .amdhsa_kernarg_size 80
  .amdhsa_user_sgpr_count 2
  .amdhsa_user_sgpr_kernarg_segment_ptr 1
  .amdhsa_system_sgpr_workgroup_id_x 1
.end_amdhsa_kernel
.p2align 6
.amdhsa_kernel k3_kernel
  .amdhsa_next_free_vgpr 216
  .amdhsa_next_free_sgpr 102
  .amdhsa_accum_offset 216
  .amdhsa_group_segment_fixed_size 0
  .amdhsa_kernarg_size 80
  .amdhsa_user_sgpr_count 2
  .amdhsa_user_sgpr_kernarg_segment_ptr 1
  .amdhsa_system_sgpr_workgroup_id_x 1
.end_amdhsa_kernel
```
